```python
import torch

def _softmax(x, axis=-1):
    return torch.softmax(x, dim=axis)
def _gelu(x):
    return torch.nn.functional.gelu(x, approximate="tanh")
def _silu(x):
    return torch.nn.functional.silu(x)
def _sigmoid(x):
    return torch.sigmoid(x)
def _layernorm(x, axis=-1, eps=1e-5):
    m = x.mean(dim=axis, keepdim=True)
    v = x.var(dim=axis, keepdim=True, unbiased=False)
    return (x - m) / torch.sqrt(v + eps)
def _scatter_add(tgt, idx, src, axis=0):
    return tgt.clone().index_add_(axis, idx, src)
def _segment_sum(src, seg, n):
    out = torch.zeros((n,) + src.shape[1:], dtype=src.dtype)
    return out.index_add_(0, seg, src)
def _pad(x, pw):
    flat = tuple(v for pair in reversed(pw) for v in pair)
    return torch.nn.functional.pad(x, flat)

kernel_name = 'recurrent_scan__ssm_conv_h3__mixer_channel_mlp__prompt'

def setup_inputs():

    _w = (lambda a: (lambda t: t.to(torch.bfloat16) if t.is_floating_point() else t)(torch.as_tensor(a)))
    def _A_setup():
        B, S, D = 1, 2048, 512
        ks = 4
        return {
            "q": _w((lambda *s: torch.randn(*s, dtype=torch.bfloat16) * 0.05)(B, S, D)),
            "k": _w((lambda *s: torch.randn(*s, dtype=torch.bfloat16) * 0.8)(B, S, D)),
            "v": _w((lambda *s: torch.randn(*s, dtype=torch.bfloat16) * 0.8)(B, S, D)),
            "shift_k": _w((lambda *s: torch.randn(*s, dtype=torch.bfloat16) * 0.8)(D, ks) * 0.5),
            "ssm_k": _w((lambda *s: torch.randn(*s, dtype=torch.bfloat16) * 0.8)(D, S) * (1.0 / S ** 0.5)),
            "ssm_D": _w((lambda *s: torch.randn(*s, dtype=torch.bfloat16) * 0.8)(D)),
        }
    _A_in = _A_setup()

    def _B_setup():
        B, S, D, F = 1, 2048, 512, 1376
        return {
            "x": _w((lambda *s: torch.randn(*s, dtype=torch.bfloat16) * 0.05)(B, S, D)),
            "w1": _w((lambda *s: torch.randn(*s, dtype=torch.bfloat16) * 0.8)(D, F) * (D ** -0.5)),
            "b1": _w((lambda *s: torch.randn(*s, dtype=torch.bfloat16) * 0.4)(F)),
            "w2": _w((lambda *s: torch.randn(*s, dtype=torch.bfloat16) * 0.2)(F, D) * (F ** -0.5)),
            "b2": _w((lambda *s: torch.randn(*s, dtype=torch.bfloat16) * 0.2)(D)),
        }
    _B_in = _B_setup()

    return {
        "A_q": _A_in["q"],
        "A_k": _A_in["k"],
        "A_v": _A_in["v"],
        "A_shift_k": _A_in["shift_k"],
        "A_ssm_k": _A_in["ssm_k"],
        "A_ssm_D": _A_in["ssm_D"],
        "B_x": _B_in["x"],
        "B_w1": _B_in["w1"],
        "B_b1": _B_in["b1"],
        "B_w2": _B_in["w2"],
        "B_b2": _B_in["b2"],
    }

def reference(A_q, A_k, A_v, A_shift_k, A_ssm_k, A_ssm_D, B_x, B_w1, B_b1, B_w2, B_b2):
    def _A_ref(q, k, v, shift_k, ssm_k, ssm_D):
        B, S, D = q.shape
        ks = shift_k.shape[-1]
        k_pad = _pad(k, ((0, 0), (ks - 1, 0), (0, 0)))
        k_shift = torch.zeros_like(k)
        for t in range(ks):
            k_shift = k_shift + k_pad[:, t:t + S, :] * shift_k[:, ks - 1 - t][None, None, :]
        kv = k_shift * v
        L = 2 * S
        kv_pad = _pad(kv, ((0, 0), (0, S), (0, 0)))
        kf_pad = _pad(ssm_k, ((0, 0), (0, S)))
        kv_f = (lambda x, axes=(-2,-1): torch.fft.rfft2(x.float(), dim=axes))(kv_pad[:, None, :, :], axes=(1, 2))
        kf_f = (lambda x, axes=(-2,-1): torch.fft.rfft2(x.float(), dim=axes))(kf_pad[:, None, :], axes=(1, 2))
        kf_f = (lambda x, *d: x.permute(*d))(kf_f, 1, 2, 0)
        y_f = kv_f * kf_f[None, :, :, :]
        y = (lambda x, s, axes=(-2,-1): torch.fft.irfft2(x, s=s, dim=axes).to(torch.bfloat16))(y_f, (1, L), axes=(1, 2))[:, 0, :S, :]
        y = y + kv * ssm_D[None, None, :]
        return q * y

    def _B_ref(x, w1, b1, w2, b2):
        y = _layernorm(x, axis=-1)
        h = _gelu(torch.einsum("bsd,df->bsf", y, w1) + b1)
        return torch.einsum("bsf,fd->bsd", h, w2) + b2

    x = A_q
    xn = _layernorm(x, axis=-1)
    s = _A_ref(xn, A_k, A_v, A_shift_k, A_ssm_k, A_ssm_D)
    g = _silu(_B_ref(xn, B_w1, B_b1, B_w2, B_b2))
    return x + s * g
```

```asm
; @launch grid=(256,1,1) block=(256,1,1) lds=158336
.amdgcn_target "amdgcn-amd-amdhsa--gfx950"
.text
.globl recurrent_scan__ssm_conv_h3__mixer_channel_mlp__prompt_kernel
.p2align 8
.type recurrent_scan__ssm_conv_h3__mixer_channel_mlp__prompt_kernel,@function
recurrent_scan__ssm_conv_h3__mixer_channel_mlp__prompt_kernel:
    s_load_dwordx16 s[8:23], s[0:1], 0
    s_load_dwordx8 s[24:31], s[0:1], 64
    s_load_dwordx4 s[32:35], s[0:1], 96
    s_cmp_ge_u32 s2, 256
    s_cbranch_scc1 L_end
    s_lshr_b32 s4, s2, 3
    v_lshrrev_b32 v4, 4, v0
    s_and_b32 s5, s4, 15
    v_lshl_add_u32 v4, v4, 4, s5
    v_lshlrev_b32 v4, 7, v4
    v_min_u32 v4, 20048, v4
    s_getpc_b64 s[6:7]
    global_load_dword v29, v4, s[6:7]
    v_and_b32 v1, 63, v0
    v_lshrrev_b32 v2, 6, v0
    s_and_b32 s3, s2, 7
    v_readfirstlane_b32 s36, v2
    s_lshr_b32 s5, s3, 1
    s_lshl_b32 s5, s5, 2
    s_lshr_b32 s6, s4, 3
    s_add_u32 s37, s5, s6
    s_and_b32 s5, s3, 1
    s_lshl_b32 s5, s5, 3
    s_add_u32 s6, s4, 0
    s_and_b32 s6, s6, 7
    s_add_u32 s38, s5, s6
    s_lshl_b32 s5, s37, 1
    s_add_u32 s41, s5, s38
    s_and_b32 s41, s41, 7
    s_lshr_b32 s5, s38, 3
    s_lshl_b32 s39, s37, 1
    s_add_u32 s39, s39, s5
    s_and_b32 s40, s38, 7
    v_lshrrev_b32 v6, 3, v1
    v_and_b32 v7, 7, v1
    s_lshl_b32 s5, s39, 2
    s_add_u32 s44, s5, s36
    s_lshl_b32 s5, s44, 14
    s_lshl_b32 s45, s40, 7
    s_add_u32 s46, s5, s45
    s_mul_i32 s47, s36, 12288
    s_add_u32 s47, s47, 98816
    s_mov_b32 s70, 2097152
    s_mov_b32 s71, 0x00020000
    s_mov_b32 s74, 1409024
    s_mov_b32 s75, 0x00020000
    s_mul_i32 s42, s38, 3
    s_lshr_b32 s5, s38, 2
    s_sub_u32 s42, s42, s5
    s_min_u32 s5, s38, 1
    s_sub_u32 s42, s42, s5
    s_bitcmp1_b32 0x8889, s38
    s_cselect_b32 s43, 2, 3
    s_lshl_b32 s6, s43, 2
    v_add_u32 v2, 0, v1
    v_mul_u32_u24 v3, 43691, v2
    v_lshrrev_b32 v3, 19, v3
    v_mul_u32_u24 v4, 12, v3
    v_sub_u32 v4, v2, v4
    v_lshrrev_b32 v5, 2, v3
    v_and_b32 v5, 2, v5
    v_xor_b32 v4, v4, v5
    v_mul_u32_u24 v3, 2752, v3
    v_lshl_add_u32 v3, v4, 4, v3
    v_cmp_le_u32 vcc, s6, v4
    v_subrev_u32 v3, 0, v3
    v_bfrev_b32 v5, 2
    v_cndmask_b32 v75, v3, v5, vcc
    v_add_u32 v2, 64, v1
    v_mul_u32_u24 v3, 43691, v2
    v_lshrrev_b32 v3, 19, v3
    v_mul_u32_u24 v4, 12, v3
    v_sub_u32 v4, v2, v4
    v_lshrrev_b32 v5, 2, v3
    v_and_b32 v5, 2, v5
    v_xor_b32 v4, v4, v5
    v_mul_u32_u24 v3, 2752, v3
    v_lshl_add_u32 v3, v4, 4, v3
    v_cmp_le_u32 vcc, s6, v4
    v_subrev_u32 v3, 1024, v3
    v_bfrev_b32 v5, 2
    v_cndmask_b32 v76, v3, v5, vcc
    v_add_u32 v2, 128, v1
    v_mul_u32_u24 v3, 43691, v2
    v_lshrrev_b32 v3, 19, v3
    v_mul_u32_u24 v4, 12, v3
    v_sub_u32 v4, v2, v4
    v_lshrrev_b32 v5, 2, v3
    v_and_b32 v5, 2, v5
    v_xor_b32 v4, v4, v5
    v_mul_u32_u24 v3, 2752, v3
    v_lshl_add_u32 v3, v4, 4, v3
    v_cmp_le_u32 vcc, s6, v4
    v_subrev_u32 v3, 2048, v3
    v_bfrev_b32 v5, 2
    v_cndmask_b32 v77, v3, v5, vcc
    s_lshl_b32 s6, s42, 6
    s_lshl_b32 s5, s37, 2
    s_add_u32 s5, s5, s36
    s_lshl_b32 s58, s5, 15
    s_lshl_b32 s59, s41, 7
    s_mul_i32 s7, s36, 44032
    s_add_u32 s7, s7, s6
    s_add_u32 s81, s7, 1409024
    s_mul_i32 s5, s41, 176128
    s_add_u32 s80, s5, s7
    s_mul_i32 s57, s36, 3072
    s_add_u32 s57, s57, 49664
    v_lshrrev_b32 v2, 1, v6
    v_xor_b32 v2, v2, v7
    v_lshlrev_b32 v2, 4, v2
    v_lshl_add_u32 v34, v6, 10, v2
    v_xor_b32 v3, 64, v34
    v_add_u32 v35, 7168, v3
    v_add_u32 v36, 14336, v34
    v_add_u32 v37, 21504, v3
    s_waitcnt lgkmcnt(0)
    s_mov_b64 s[68:69], s[8:9]
    s_mov_b64 s[72:73], s[22:23]
    s_mov_b64 s[76:77], s[34:35]
    s_mov_b32 s78, 13631488
    s_mov_b32 s79, 0x00020000
    v_mov_b32 v8, 0
    s_mov_b32 s3, 11534336
    s_mov_b64 exec, 1
    buffer_load_dwordx2 v[62:63], v8, s[76:79], s3 offen sc1
    s_mov_b64 exec, -1
    v_lshrrev_b32 v2, 5, v1
    v_and_b32 v3, 31, v1
    v_lshlrev_b32 v3, 4, v3
    v_lshl_add_u32 v3, v2, 10, v3
    s_lshl_b32 s5, s37, 4
    s_add_u32 s5, s5, s38
    s_lshl_b32 s5, s5, 2
    s_add_u32 s5, s5, s36
    s_lshl_b32 s6, s5, 11
    buffer_load_dwordx4 v[200:203], v3, s[68:71], s6 offen
    buffer_load_dwordx4 v[204:207], v3, s[68:71], s6 offen offset:512
    s_lshl_b32 s5, s5, 6
    s_add_u32 s5, s5, 11403264
    v_lshl_add_u32 v28, v1, 4, s5
    s_add_u32 m0, s47, 0
    s_or_b32 s49, s59, s58
    buffer_load_dwordx4 v34, s[68:71], s49 offen offset:0  lds
    buffer_load_dwordx4 v35, s[68:71], s49 offen offset:1024  lds
    s_add_u32 s59, s59, 128
    buffer_load_dwordx4 v36, s[68:71], s49 offen offset:2048  lds
    s_and_b32 s59, s59, 0x3ff
    buffer_load_dwordx4 v37, s[68:71], s49 offen offset:3072  lds
    s_add_u32 m0, s57, 0
    s_nop 0
    buffer_load_dwordx4 v75, s[72:75], s80 offen offset:0 lds
    buffer_load_dwordx4 v76, s[72:75], s80 offen offset:1024 lds
    buffer_load_dwordx4 v77, s[72:75], s80 offen offset:2048 lds
    s_add_u32 s80, s80, 176128
    s_add_u32 m0, s57, 12288
    s_cmp_ge_u32 s80, s81
    s_cselect_b32 s5, 1409024, 0
    s_sub_u32 s80, s80, s5
    buffer_load_dwordx4 v75, s[72:75], s80 offen offset:0 lds
    buffer_load_dwordx4 v76, s[72:75], s80 offen offset:1024 lds
    buffer_load_dwordx4 v77, s[72:75], s80 offen offset:2048 lds
    s_add_u32 s80, s80, 176128
    s_lshl_b32 s5, s2, 2
    s_load_dword s82, s[18:19], s5
    v_lshlrev_b32 v3, 4, v7
    v_lshl_add_u32 v2, v6, 11, v3
    s_xor_b32 s7, s46, 512
    v_add_u32 v61, s7, v2
    v_lshl_add_u32 v2, v6, 10, v3
    v_add_u32 v79, s7, v2
    v_subrev_u32 v78, 8192, v79
    v_lshlrev_b32 v11, 4, v1
    s_lshl_b32 s6, s40, 9
    s_xor_b32 s6, s6, 2048
    v_add_u32 v80, s6, v11
    v_mov_b32 v8, 0
    s_and_b32 s8, s36, 1
    s_lshr_b32 s9, s36, 1
    s_lshl_b32 s5, s2, 1
    s_add_u32 s18, s5, s9
    s_lshl_b32 s18, s18, 12
    s_add_u32 s16, s16, s18
    s_addc_u32 s17, s17, 0
    s_lshl_b32 s6, s8, 11
    v_add_u32 v81, s6, v11
    v_subrev_u32 v96, 8, v81
    s_lshl_b32 s19, s36, 12
    s_add_u32 s19, s19, 33280
    s_mov_b64 s[60:61], s[10:11]
    s_mov_b32 s62, 2097152
    s_mov_b32 s63, 0x00020000
    s_mov_b64 s[64:65], s[12:13]
    s_mov_b32 s66, 2097152
    s_mov_b32 s67, 0x00020000
    v_and_b32 v9, 15, v1
    v_lshrrev_b32 v10, 4, v1
    v_add_u32 v12, s47, v11
    v_lshlrev_b32 v2, 4, v7
    v_lshl_add_u32 v2, v6, 8, v2
    v_add_u32 v102, s19, v2
    v_lshl_add_u32 v103, v7, 6, s19
    v_lshrrev_b32 v2, 1, v9
    v_xor_b32 v2, v2, v10
    v_lshlrev_b32 v2, 4, v2
    v_lshl_add_u32 v2, v9, 7, v2
    v_add_u32 v64, s47, v2
    v_xor_b32 v65, 64, v64
    v_lshrrev_b32 v2, 2, v9
    v_lshl_add_u32 v2, v10, 3, v2
    v_mul_u32_u24 v2, 192, v2
    v_and_b32 v3, 3, v1
    v_lshl_add_u32 v2, v3, 3, v2
    v_add_u32 v2, 49664, v2
    v_and_b32 v3, 1, v10
    v_lshlrev_b32 v3, 5, v3
    v_add_u32 v4, v2, v3
    v_sub_u32 v5, v2, v3
    s_add_u32 s5, s36, 0
    s_cmp_ge_u32 s5, 3
    s_cselect_b32 s6, 3, 0
    s_sub_u32 s20, s5, s6
    s_lshl_b32 s5, s20, 6
    v_add_u32 v66, s5, v4
    v_add_u32 v67, s5, v5
    s_add_u32 s5, s36, 1
    s_cmp_ge_u32 s5, 3
    s_cselect_b32 s6, 3, 0
    s_sub_u32 s21, s5, s6
    s_lshl_b32 s5, s21, 6
    v_add_u32 v68, s5, v4
    v_add_u32 v69, s5, v5
    s_add_u32 s5, s36, 2
    s_cmp_ge_u32 s5, 3
    s_cselect_b32 s6, 3, 0
    s_sub_u32 s22, s5, s6
    s_lshl_b32 s5, s22, 6
    v_add_u32 v70, s5, v4
    v_add_u32 v71, s5, v5
    v_mul_u32_u24 v2, 1040, v7
    v_lshlrev_b32 v3, 2, v6
    v_sub_u32 v2, v2, v3
    s_lshl_b32 s5, s36, 5
    s_sub_u32 s5, 148092, s5
    v_add_u32 v99, s5, v2
    s_mul_i32 s5, s36, 2080
    s_add_u32 s5, s5, 147968
    v_add_u32 v100, s5, v11
    v_mul_u32_u24 v2, 4352, v6
    v_lshl_add_u32 v101, v7, 4, v2
    v_mov_b32 v2, 0x3f803f80
    v_accvgpr_write_b32 a244, v2
    v_accvgpr_write_b32 a245, v2
    v_accvgpr_write_b32 a246, v2
    v_accvgpr_write_b32 a247, v2
    s_mov_b32 s48, 0xffff0000
    s_lshl_b32 s5, s40, 2
    s_xor_b32 s5, s5, 16
    s_add_u32 s5, s5, s36
    s_mul_i32 s50, s5, 2304
    s_lshl_b32 s6, s39, 6
    s_add_u32 s50, s50, s6
    s_add_u32 s50, s50, 10747904
    s_mul_i32 s5, s5, 69632
    s_sub_u32 s6, 31, s39
    s_lshl_b32 s6, s6, 7
    s_add_u32 s23, s5, s6
    v_min_u32 v2, 47, v1
    v_lshlrev_b32 v104, 3, v2
    v_add_u32 v104, 157696, v104
    s_lshl_b32 s5, s42, 6
    v_lshl_add_u32 v97, v2, 2, s5
    v_min_u32 v97, 2748, v97
    v_and_b32 v2, 31, v1
    v_lshlrev_b32 v105, 3, v2
    v_add_u32 v105, 158080, v105
    v_lshl_add_u32 v98, v2, 2, s45
    s_mov_b32 s90, 0xaaaaaaaa
    s_mov_b32 s91, 0xaaaaaaaa
    s_add_u32 m0, s47, 4096
    s_or_b32 s49, s59, s58
    buffer_load_dwordx4 v34, s[68:71], s49 offen offset:0  lds
    buffer_load_dwordx4 v35, s[68:71], s49 offen offset:1024  lds
    s_add_u32 s59, s59, 128
    buffer_load_dwordx4 v36, s[68:71], s49 offen offset:2048  lds
    s_and_b32 s59, s59, 0x3ff
    buffer_load_dwordx4 v37, s[68:71], s49 offen offset:3072  lds
    v_and_b32 v2, 6, v6
    v_xor_b32 v2, v2, v7
    v_lshlrev_b32 v2, 4, v2
    v_lshl_add_u32 v38, v6, 10, v2
    v_add_u32 v38, s45, v38
    v_add_u32 v39, 7168, v38
    v_add_u32 v40, 14336, v38
    v_add_u32 v41, 21504, v38
    v_lshrrev_b32 v2, 2, v9
    v_lshl_add_u32 v2, v10, 2, v2
    v_lshrrev_b32 v3, 1, v2
    v_and_b32 v3, 3, v3
    v_lshlrev_b32 v3, 5, v3
    v_lshl_add_u32 v3, v2, 7, v3
    v_and_b32 v2, 3, v1
    v_lshl_add_u32 v3, v2, 3, v3
    v_add_u32 v42, s47, v3
    s_lshl_b32 s32, s36, 12
    v_add_u32 v46, s32, v3
    v_xor_b32 v43, 32, v42
    v_xor_b32 v47, 32, v46
    v_xor_b32 v44, 64, v42
    v_xor_b32 v48, 64, v46
    v_xor_b32 v45, 96, v42
    v_xor_b32 v49, 96, v46
    s_lshr_b32 s10, s4, 3
    s_mul_i32 s10, s10, 3
    s_mul_i32 s11, s40, 11
    s_lshr_b32 s11, s11, 3
    s_add_u32 s10, s10, s11
    s_cmp_ge_u32 s10, 11
    s_cselect_b32 s11, 11, 0
    s_sub_u32 s10, s10, s11
    s_mul_i32 s12, s36, 11
    s_add_u32 s10, s10, s12
    s_add_u32 s12, s12, 11
    s_lshl_b32 s33, s10, 15
    s_add_u32 s10, s10, 1
    s_cmp_ge_u32 s10, s12
    s_cselect_b32 s11, 11, 0
    s_sub_u32 s10, s10, s11
    s_lshl_b32 s34, s10, 15
    s_add_u32 s10, s10, 1
    s_cmp_ge_u32 s10, s12
    s_cselect_b32 s11, 11, 0
    s_sub_u32 s10, s10, s11
    s_lshl_b32 s35, s10, 15
    s_add_u32 s10, s10, 1
    s_cmp_ge_u32 s10, s12
    s_cselect_b32 s11, 11, 0
    s_sub_u32 s10, s10, s11
    s_lshl_b32 s41, s10, 15
    s_add_u32 s10, s10, 1
    s_cmp_ge_u32 s10, s12
    s_cselect_b32 s11, 11, 0
    s_sub_u32 s10, s10, s11
    s_lshl_b32 s83, s10, 15
    s_add_u32 s10, s10, 1
    s_cmp_ge_u32 s10, s12
    s_cselect_b32 s11, 11, 0
    s_sub_u32 s10, s10, s11
    s_lshl_b32 s84, s10, 15
    s_add_u32 s10, s10, 1
    s_cmp_ge_u32 s10, s12
    s_cselect_b32 s11, 11, 0
    s_sub_u32 s10, s10, s11
    s_lshl_b32 s85, s10, 15
    s_add_u32 s10, s10, 1
    s_cmp_ge_u32 s10, s12
    s_cselect_b32 s11, 11, 0
    s_sub_u32 s10, s10, s11
    s_lshl_b32 s86, s10, 15
    s_add_u32 s10, s10, 1
    s_cmp_ge_u32 s10, s12
    s_cselect_b32 s11, 11, 0
    s_sub_u32 s10, s10, s11
    s_lshl_b32 s87, s10, 15
    s_add_u32 s10, s10, 1
    s_cmp_ge_u32 s10, s12
    s_cselect_b32 s11, 11, 0
    s_sub_u32 s10, s10, s11
    s_lshl_b32 s88, s10, 15
    s_add_u32 s10, s10, 1
    s_cmp_ge_u32 s10, s12
    s_cselect_b32 s11, 11, 0
    s_sub_u32 s10, s10, s11
    s_lshl_b32 s89, s10, 15
    v_lshrrev_b32 v3, 1, v10
    s_lshr_b32 s11, s58, 5
    s_add_u32 s11, s11, 11403264
    v_lshl_add_u32 v26, v9, 5, s11
    v_lshl_add_u32 v26, v3, 9, v26
    v_lshlrev_b32 v2, 4, v10
    v_add_u32 v27, 156288, v2
    s_lshl_b32 s11, s37, 2
    s_add_u32 s11, s11, s36
    s_mul_i32 s11, s11, 86
    s_add_u32 s11, s11, s42
    s_lshl_b32 s12, s20, 7
    v_add_u32 v72, s12, v27
    s_add_u32 s12, s11, s20
    s_lshl_b32 s12, s12, 10
    s_add_u32 s12, s12, 2359296
    s_cmp_lt_u32 s20, s43
    s_cselect_b32 s20, s12, 0x7f000000
    s_lshl_b32 s12, s21, 7
    v_add_u32 v73, s12, v27
    s_add_u32 s12, s11, s21
    s_lshl_b32 s12, s12, 10
    s_add_u32 s12, s12, 2359296
    s_cmp_lt_u32 s21, s43
    s_cselect_b32 s21, s12, 0x7f000000
    s_lshl_b32 s12, s22, 7
    v_add_u32 v74, s12, v27
    s_add_u32 s12, s11, s22
    s_lshl_b32 s12, s12, 10
    s_add_u32 s12, s12, 2359296
    s_cmp_lt_u32 s22, s43
    s_cselect_b32 s22, s12, 0x7f000000
    v_accvgpr_write_b32 a248, 0
    v_accvgpr_write_b32 a249, 0
    v_accvgpr_write_b32 a250, 0
    v_accvgpr_write_b32 a251, 0
    s_waitcnt vmcnt(14)
    s_mov_b32 s5, 0x3f803f80
    v_dot2_f32_bf16 v82, v200, s5, 0
    v_dot2_f32_bf16 v84, v200, v200, 0
    v_dot2_f32_bf16 v83, v201, s5, 0
    v_dot2_f32_bf16 v85, v201, v201, 0
    v_dot2_f32_bf16 v82, v202, s5, v82
    v_dot2_f32_bf16 v84, v202, v202, v84
    v_dot2_f32_bf16 v83, v203, s5, v83
    v_dot2_f32_bf16 v85, v203, v203, v85
    v_dot2_f32_bf16 v82, v204, s5, v82
    v_dot2_f32_bf16 v84, v204, v204, v84
    v_dot2_f32_bf16 v83, v205, s5, v83
    v_dot2_f32_bf16 v85, v205, v205, v85
    v_dot2_f32_bf16 v82, v206, s5, v82
    v_dot2_f32_bf16 v84, v206, v206, v84
    v_dot2_f32_bf16 v83, v207, s5, v83
    v_dot2_f32_bf16 v85, v207, v207, v85
    v_readfirstlane_b32 s0, v62
    v_readfirstlane_b32 s1, v63
    s_waitcnt vmcnt(10)
    ds_read_b128 a[64:67], v64 offset:0
    ds_read_b128 a[68:71], v64 offset:2048
    ds_read_b128 a[72:75], v65 offset:0
    ds_read_b128 a[76:79], v65 offset:2048
    s_mul_i32 s0, s0, 0x9E3779B1
    s_mul_i32 s1, s1, 0x85EBCA6D
    s_add_u32 s0, s0, 0x7F4A7C15
    s_add_u32 s1, s1, 0x165667B1
    v_add_f32 v82, v82, v83
    v_add_f32 v84, v84, v85
    v_mov_b32 v30, s0
    v_mov_b32 v32, s0
    v_mov_b32 v92, s0
    v_mov_b32 v31, s1
    v_mov_b32 v33, s1
    v_mov_b32 v93, s1
    s_waitcnt vmcnt(7)
    s_barrier
    ds_read_b64_tr_b16 a[128:129], v66 offset:0
    ds_read_b64_tr_b16 a[130:131], v66 offset:768
    ds_read_b64_tr_b16 a[132:133], v67 offset:32
    ds_read_b64_tr_b16 a[134:135], v67 offset:800
    ds_read_b64_tr_b16 a[136:137], v68 offset:0
    ds_read_b64_tr_b16 a[138:139], v68 offset:768
    ds_read_b64_tr_b16 a[140:141], v69 offset:32
    ds_read_b64_tr_b16 a[142:143], v69 offset:800
    ds_read_b64_tr_b16 a[144:145], v70 offset:0
    ds_read_b64_tr_b16 a[146:147], v70 offset:768
    ds_read_b64_tr_b16 a[148:149], v71 offset:32
    ds_read_b64_tr_b16 a[150:151], v71 offset:800
    s_add_u32 m0, s57, 24576
    s_cmp_ge_u32 s80, s81
    s_cselect_b32 s5, 1409024, 0
    s_sub_u32 s80, s80, s5
    buffer_load_dwordx4 v75, s[72:75], s80 offen offset:0 lds
    buffer_load_dwordx4 v76, s[72:75], s80 offen offset:1024 lds
    buffer_load_dwordx4 v77, s[72:75], s80 offen offset:2048 lds
    s_add_u32 s80, s80, 176128
    s_add_u32 m0, s47, 8192
    s_or_b32 s49, s59, s58
    buffer_load_dwordx4 v34, s[68:71], s49 offen offset:0  lds
    buffer_load_dwordx4 v35, s[68:71], s49 offen offset:1024  lds
    s_add_u32 s59, s59, 128
    buffer_load_dwordx4 v36, s[68:71], s49 offen offset:2048  lds
    s_and_b32 s59, s59, 0x3ff
    buffer_load_dwordx4 v37, s[68:71], s49 offen offset:3072  lds
    s_waitcnt lgkmcnt(0)
    v_mfma_f32_16x16x32_bf16 v[106:109], a[128:131], a[64:67], 0
    ds_read_b64_tr_b16 a[152:153], v66 offset:6144
    v_add_f32_dpp v82, v82, v82 row_ror:8 row_mask:0xf bank_mask:0xf
    v_mfma_f32_16x16x32_bf16 v[110:113], a[128:131], a[68:71], 0
    v_add_f32_dpp v84, v84, v84 row_ror:8 row_mask:0xf bank_mask:0xf
    v_mfma_f32_16x16x32_bf16 v[114:117], a[132:135], a[64:67], 0
    ds_read_b64_tr_b16 a[154:155], v66 offset:6912
    s_add_u32 m0, s19, 1024
    s_mov_b32 s3, 7168
    buffer_load_dwordx4 v79, s[60:63], 0 offen nt lds
    v_add_f32_dpp v82, v82, v82 row_ror:4 row_mask:0xf bank_mask:0xf
    v_mfma_f32_16x16x32_bf16 v[118:121], a[132:135], a[68:71], 0
    ds_read_b64_tr_b16 a[156:157], v67 offset:6176
    v_add_f32_dpp v84, v84, v84 row_ror:4 row_mask:0xf bank_mask:0xf
    v_mfma_f32_16x16x32_bf16 v[122:125], a[136:139], a[64:67], 0
    ds_read_b64_tr_b16 a[158:159], v67 offset:6944
    buffer_load_dwordx4 v79, s[60:63], s3 offen offset:1024 nt lds
    v_add_f32_dpp v82, v82, v82 row_ror:2 row_mask:0xf bank_mask:0xf
    v_mfma_f32_16x16x32_bf16 v[126:129], a[136:139], a[68:71], 0
    ds_read_b64_tr_b16 a[160:161], v68 offset:6144
    v_add_f32_dpp v84, v84, v84 row_ror:2 row_mask:0xf bank_mask:0xf
    v_mfma_f32_16x16x32_bf16 v[130:133], a[140:143], a[64:67], 0
    ds_read_b64_tr_b16 a[162:163], v68 offset:6912
    buffer_load_dwordx4 v[246:249], v61, s[64:67], 0 offen nt
    v_add_f32_dpp v82, v82, v82 row_ror:1 row_mask:0xf bank_mask:0xf
    v_mfma_f32_16x16x32_bf16 v[134:137], a[140:143], a[68:71], 0
    ds_read_b64_tr_b16 a[164:165], v69 offset:6176
    v_add_f32_dpp v84, v84, v84 row_ror:1 row_mask:0xf bank_mask:0xf
    v_mfma_f32_16x16x32_bf16 v[138:141], a[144:147], a[64:67], 0
    ds_read_b64_tr_b16 a[166:167], v69 offset:6944
    v_mov_b32 v83, v82
    v_mfma_f32_16x16x32_bf16 v[142:145], a[144:147], a[68:71], 0
    ds_read_b64_tr_b16 a[168:169], v70 offset:6144
    buffer_load_dwordx4 v[250:253], v61, s[64:67], 0 offen offset:1024 nt
    v_mov_b32 v85, v84
    v_mfma_f32_16x16x32_bf16 v[146:149], a[148:151], a[64:67], 0
    ds_read_b64_tr_b16 a[170:171], v70 offset:6912
    v_permlane16_swap_b32 v82, v83
    v_mfma_f32_16x16x32_bf16 v[150:153], a[148:151], a[68:71], 0
    ds_read_b64_tr_b16 a[172:173], v71 offset:6176
    s_mov_b32 m0, s19
    s_mov_b32 exec_lo, 0
    s_mov_b32 exec_hi, 0xffffff00
    buffer_load_dwordx4 v78, s[60:63], 0 offen lds
    s_mov_b64 exec, -1
    v_permlane16_swap_b32 v84, v85
    v_mfma_f32_16x16x32_bf16 a[192:195], a[128:131], a[244:247], 0
    ds_read_b64_tr_b16 a[174:175], v71 offset:6944
    v_add_f32 v86, v82, v83
    v_mfma_f32_16x16x32_bf16 a[196:199], a[132:135], a[244:247], 0
    s_add_u32 m0, s19, 3072
    s_mov_b64 s[60:61], s[14:15]
    s_mov_b32 s62, 4096
    s_mov_b32 exec_hi, 0
    buffer_load_dwordx4 v80, s[60:63], 0 offen lds
    s_mov_b64 exec, -1
    s_mov_b64 s[60:61], s[16:17]
    s_mov_b64 s[64:65], s[26:27]
    s_mov_b32 s66, 1409024
    v_add_f32 v87, v84, v85
    s_waitcnt vmcnt(17)
    s_barrier
    v_mul_f32 v86, 0x3b000000, v86
    s_waitcnt lgkmcnt(10)
    v_mfma_f32_16x16x32_bf16 v[106:109], a[152:155], a[72:75], v[106:109]
    ds_read_b64_tr_b16 a[128:129], v66 offset:12288
    v_mul_f32 v87, 0x3b000000, v87
    v_mfma_f32_16x16x32_bf16 v[110:113], a[152:155], a[76:79], v[110:113]
    ds_read_b64_tr_b16 a[130:131], v66 offset:13056
    s_waitcnt vmcnt(13)
    v_cvt_pk_bf16_f32 v94, v86, v86
    s_waitcnt lgkmcnt(10)
    v_mfma_f32_16x16x32_bf16 v[114:117], a[156:159], a[72:75], v[114:117]
    ds_read_b64_tr_b16 a[132:133], v67 offset:12320
    ds_read_b128 a[80:83], v64 offset:4096
    v_and_b32 v94, s48, v94
    v_mfma_f32_16x16x32_bf16 v[118:121], a[156:159], a[76:79], v[118:121]
    ds_read_b64_tr_b16 a[134:135], v67 offset:13088
    ds_read_b128 a[84:87], v64 offset:6144
    v_fma_f32 v87, -v86, v86, v87
    v_max_f32 v87, 0, v87
    s_waitcnt lgkmcnt(12)
    v_mfma_f32_16x16x32_bf16 v[122:125], a[160:163], a[72:75], v[122:125]
    ds_read_b64_tr_b16 a[136:137], v68 offset:12288
    ds_read_b128 a[88:91], v65 offset:4096
    s_add_u32 m0, s57, 36864
    s_cmp_ge_u32 s80, s81
    s_cselect_b32 s5, 1409024, 0
    s_sub_u32 s80, s80, s5
    buffer_load_dwordx4 v75, s[72:75], s80 offen offset:0 lds
    v_cvt_pk_bf16_f32 v88, v87, v87
    v_mfma_f32_16x16x32_bf16 v[126:129], a[160:163], a[76:79], v[126:129]
    ds_read_b64_tr_b16 a[138:139], v68 offset:13056
    ds_read_b128 a[92:95], v65 offset:6144
    v_and_b32 v88, s48, v88
    s_waitcnt lgkmcnt(14)
    v_mfma_f32_16x16x32_bf16 v[130:133], a[164:167], a[72:75], v[130:133]
    v_add_f32 v88, 0x3727c5ac, v88
    ds_read_b64_tr_b16 a[140:141], v69 offset:12320
    v_mfma_f32_16x16x32_bf16 v[134:137], a[164:167], a[76:79], v[134:137]
    v_cvt_pk_bf16_f32 v88, v88, v88
    s_waitcnt lgkmcnt(13)
    v_mfma_f32_16x16x32_bf16 v[138:141], a[168:171], a[72:75], v[138:141]
    ds_read_b64_tr_b16 a[142:143], v69 offset:13088
    buffer_load_dwordx4 v76, s[72:75], s80 offen offset:1024 lds
    v_and_b32 v88, s48, v88
    v_mfma_f32_16x16x32_bf16 v[142:145], a[168:171], a[76:79], v[142:145]
    ds_read_b64_tr_b16 a[144:145], v70 offset:12288
    v_sqrt_f32 v88, v88
    s_waitcnt lgkmcnt(13)
    v_mfma_f32_16x16x32_bf16 v[146:149], a[172:175], a[72:75], v[146:149]
    ds_read_b64_tr_b16 a[146:147], v70 offset:13056
    v_sub_f32 v86, v86, v94
    v_mfma_f32_16x16x32_bf16 v[150:153], a[172:175], a[76:79], v[150:153]
    ds_read_b64_tr_b16 a[148:149], v71 offset:12320
    v_cvt_pk_bf16_f32 v88, v88, v88
    v_mfma_f32_16x16x32_bf16 a[192:195], a[152:155], a[244:247], a[192:195]
    ds_read_b64_tr_b16 a[150:151], v71 offset:13088
    buffer_load_dwordx4 v77, s[72:75], s80 offen offset:2048 lds
    s_add_u32 s80, s80, 176128
    v_and_b32 v88, s48, v88
    v_mfma_f32_16x16x32_bf16 a[196:199], a[156:159], a[244:247], a[196:199]
    v_rcp_f32 v95, v88
    s_waitcnt lgkmcnt(6)
    v_mfma_f32_16x16x32_bf16 v[106:109], a[128:131], a[80:83], v[106:109]
    v_mul_f32 v86, v86, v95
    ds_read_b64_tr_b16 a[152:153], v66 offset:18432
    v_mfma_f32_16x16x32_bf16 v[110:113], a[128:131], a[84:87], v[110:113]
    ds_read_b64_tr_b16 a[154:155], v66 offset:19200
    v_mul_f32 v87, v87, v95
    v_mfma_f32_16x16x32_bf16 v[114:117], a[132:135], a[80:83], v[114:117]
    ds_read_b64_tr_b16 a[156:157], v67 offset:18464
    v_mul_f32 v87, v87, v95
    v_mfma_f32_16x16x32_bf16 v[118:121], a[132:135], a[84:87], v[118:121]
    ds_read_b64_tr_b16 a[158:159], v67 offset:19232
    s_add_u32 m0, s47, 0
    s_or_b32 s49, s59, s58
    buffer_load_dwordx4 v34, s[68:71], s49 offen offset:0  lds
    v_cvt_pk_bf16_f32 v88, v87, v87
    v_mfma_f32_16x16x32_bf16 v[122:125], a[136:139], a[80:83], v[122:125]
    ds_read_b64_tr_b16 a[160:161], v68 offset:18432
    v_and_b32 v88, s48, v88
    v_mfma_f32_16x16x32_bf16 v[126:129], a[136:139], a[84:87], v[126:129]
    ds_read_b64_tr_b16 a[162:163], v68 offset:19200
    v_add_f32 v88, 0x3727c5ac, v88
    s_waitcnt lgkmcnt(10)
    v_mfma_f32_16x16x32_bf16 v[130:133], a[140:143], a[80:83], v[130:133]
    ds_read_b64_tr_b16 a[164:165], v69 offset:18464
    ds_read_b64_tr_b16 a[166:167], v69 offset:19232
    buffer_load_dwordx4 v35, s[68:71], s49 offen offset:1024  lds
    s_add_u32 s59, s59, 128
    v_cvt_pk_bf16_f32 v88, v88, v88
    v_and_b32 v88, s48, v88
    v_mfma_f32_16x16x32_bf16 v[134:137], a[140:143], a[84:87], v[134:137]
    ds_read_b64_tr_b16 a[168:169], v70 offset:18432
    v_sqrt_f32 v88, v88
    s_waitcnt lgkmcnt(11)
    v_mfma_f32_16x16x32_bf16 v[138:141], a[144:147], a[80:83], v[138:141]
    ds_read_b64_tr_b16 a[170:171], v70 offset:19200
    v_cvt_pk_bf16_f32 v86, v86, v86
    v_mfma_f32_16x16x32_bf16 v[142:145], a[144:147], a[84:87], v[142:145]
    ds_read_b64_tr_b16 a[172:173], v71 offset:18464
    ds_read_b64_tr_b16 a[174:175], v71 offset:19232
    v_and_b32 v86, s48, v86
    s_waitcnt lgkmcnt(12)
    v_mfma_f32_16x16x32_bf16 v[146:149], a[148:151], a[80:83], v[146:149]
    buffer_load_dwordx4 v36, s[68:71], s49 offen offset:2048  lds
    s_and_b32 s59, s59, 0x3ff
    v_cvt_pk_bf16_f32 v88, v88, v88
    v_mfma_f32_16x16x32_bf16 v[150:153], a[148:151], a[84:87], v[150:153]
    v_and_b32 v88, s48, v88
    v_mfma_f32_16x16x32_bf16 a[192:195], a[128:131], a[244:247], a[192:195]
    v_rcp_f32 v89, v88
    v_mfma_f32_16x16x32_bf16 a[196:199], a[132:135], a[244:247], a[196:199]
    buffer_load_dwordx4 v37, s[68:71], s49 offen offset:3072  lds
    v_fma_f32 v86, v94, v95, v86
    s_waitcnt vmcnt(17) lgkmcnt(0)
    s_barrier
    v_mul_f32 v88, v95, v89
    v_mfma_f32_16x16x32_bf16 v[106:109], a[152:155], a[88:91], v[106:109]
    ds_read_b64_tr_b16 a[128:129], v66 offset:24576
    v_mul_f32 v86, v86, v89
    v_mfma_f32_16x16x32_bf16 v[110:113], a[152:155], a[92:95], v[110:113]
    ds_read_b64_tr_b16 a[130:131], v66 offset:25344
    s_waitcnt vmcnt(13)
    v_cndmask_b32 v90, v88, v94, s[90:91]
    v_mfma_f32_16x16x32_bf16 v[114:117], a[156:159], a[88:91], v[114:117]
    ds_read_b64_tr_b16 a[132:133], v67 offset:24608
    ds_read_b128 a[96:99], v64 offset:8192
    v_cndmask_b32 v91, v86, v95, s[90:91]
    v_mfma_f32_16x16x32_bf16 v[118:121], a[156:159], a[92:95], v[118:121]
    ds_read_b64_tr_b16 a[134:135], v67 offset:25376
    ds_read_b128 a[100:103], v64 offset:10240
    s_add_u32 m0, s57, 0
    s_cmp_ge_u32 s80, s81
    s_cselect_b32 s5, 1409024, 0
    s_sub_u32 s80, s80, s5
    buffer_load_dwordx4 v75, s[72:75], s80 offen offset:0 lds
    v_mov_b32 v82, v90
    v_mfma_f32_16x16x32_bf16 v[122:125], a[160:163], a[88:91], v[122:125]
    ds_read_b64_tr_b16 a[136:137], v68 offset:24576
    ds_read_b128 a[104:107], v65 offset:8192
    v_mov_b32 v84, v91
    v_mfma_f32_16x16x32_bf16 v[126:129], a[160:163], a[92:95], v[126:129]
    ds_read_b64_tr_b16 a[138:139], v68 offset:25344
    ds_read_b128 a[108:111], v65 offset:10240
    v_permlane32_swap_b32 v90, v82
    v_mfma_f32_16x16x32_bf16 v[130:133], a[164:167], a[88:91], v[130:133]
    buffer_load_dwordx4 v76, s[72:75], s80 offen offset:1024 lds
    v_permlane32_swap_b32 v91, v84
    s_mov_b64 exec, 12
    v_mov_b32 v90, v82
    v_mov_b32 v91, v84
    s_mov_b64 exec, -1
    v_mfma_f32_16x16x32_bf16 v[134:137], a[164:167], a[92:95], v[134:137]
    ds_read_b64_tr_b16 a[140:141], v69 offset:24608
    v_mfma_f32_16x16x32_bf16 v[138:141], a[168:171], a[88:91], v[138:141]
    ds_read_b64_tr_b16 a[142:143], v69 offset:25376
    v_mfma_f32_16x16x32_bf16 v[142:145], a[168:171], a[92:95], v[142:145]
    ds_read_b64_tr_b16 a[144:145], v70 offset:24576
    buffer_load_dwordx4 v77, s[72:75], s80 offen offset:2048 lds
    s_add_u32 s80, s80, 176128
    v_mfma_f32_16x16x32_bf16 v[146:149], a[172:175], a[88:91], v[146:149]
    ds_read_b64_tr_b16 a[146:147], v70 offset:25344
    v_mfma_f32_16x16x32_bf16 v[150:153], a[172:175], a[92:95], v[150:153]
    ds_read_b64_tr_b16 a[148:149], v71 offset:24608
    v_mfma_f32_16x16x32_bf16 a[192:195], a[152:155], a[244:247], a[192:195]
    ds_read_b64_tr_b16 a[150:151], v71 offset:25376
    s_mov_b64 exec, 15
    buffer_store_dwordx4 v[90:93], v28, s[76:79], 0 offen sc1
    s_mov_b64 exec, -1
    v_mfma_f32_16x16x32_bf16 a[196:199], a[156:159], a[244:247], a[196:199]
    s_waitcnt lgkmcnt(6)
    v_mfma_f32_16x16x32_bf16 v[106:109], a[128:131], a[96:99], v[106:109]
    ds_read_b64_tr_b16 a[152:153], v66 offset:30720
    s_lshl_b32 s11, s37, 1
    v_mfma_f32_16x16x32_bf16 v[110:113], a[128:131], a[100:103], v[110:113]
    ds_read_b64_tr_b16 a[154:155], v66 offset:31488
    s_waitcnt vmcnt(11)
    s_add_u32 s11, s11, s9
    v_mfma_f32_16x16x32_bf16 v[114:117], a[132:135], a[96:99], v[114:117]
    ds_read_b128 v[202:205], v103 offset:3072
    v_mfma_f32_16x16x32_bf16 v[118:121], a[132:135], a[100:103], v[118:121]
    ds_read_b64_tr_b16 a[156:157], v67 offset:30752
    ds_read_b128 v[206:209], v103 offset:3088
    v_mfma_f32_16x16x32_bf16 v[122:125], a[136:139], a[96:99], v[122:125]
    ds_read_b64_tr_b16 a[158:159], v67 offset:31520
    s_add_u32 m0, s57, 12288
    s_cmp_ge_u32 s80, s81
    s_cselect_b32 s5, 1409024, 0
    s_sub_u32 s80, s80, s5
    buffer_load_dwordx4 v75, s[72:75], s80 offen offset:0 lds
    ds_read_b128 v[210:213], v103 offset:3104
    s_mul_i32 s51, s11, 2304
    v_mfma_f32_16x16x32_bf16 v[126:129], a[136:139], a[100:103], v[126:129]
    ds_read_b64_tr_b16 a[160:161], v68 offset:30720
    ds_read_b128 v[214:217], v103 offset:3120
    s_lshl_b32 s11, s38, 1
    s_waitcnt lgkmcnt(13)
    v_mfma_f32_16x16x32_bf16 v[130:133], a[140:143], a[96:99], v[130:133]
    ds_read_b64_tr_b16 a[162:163], v68 offset:31488
    ds_read_b128 v[226:229], v102 offset:640
    ds_read_b128 v[230:233], v102 offset:768
    v_mfma_f32_16x16x32_bf16 v[134:137], a[140:143], a[100:103], v[134:137]
    ds_read_b64_tr_b16 a[164:165], v69 offset:30752
    ds_read_b128 v[234:237], v102 offset:896
    s_add_u32 s11, s11, s8
    s_waitcnt lgkmcnt(15)
    v_mfma_f32_16x16x32_bf16 v[138:141], a[144:147], a[96:99], v[138:141]
    ds_read_b64_tr_b16 a[166:167], v69 offset:31520
    buffer_load_dwordx4 v76, s[72:75], s80 offen offset:1024 lds
    ds_read_b128 v[238:241], v102 offset:1024
    ds_read_b128 v[242:245], v102 offset:1152
    s_lshl_b32 s11, s11, 6
    v_mfma_f32_16x16x32_bf16 v[142:145], a[144:147], a[100:103], v[142:145]
    ds_read_b64_tr_b16 a[168:169], v70 offset:30720
    s_add_u32 s51, s51, s11
    s_waitcnt lgkmcnt(15)
    v_mfma_f32_16x16x32_bf16 v[146:149], a[148:151], a[96:99], v[146:149]
    ds_read_b64_tr_b16 a[170:171], v70 offset:31488
    s_waitcnt lgkmcnt(10)
    v_mfma_f32_16x16x32_bf16 v[150:153], a[148:151], a[100:103], v[150:153]
    ds_read_b64_tr_b16 a[172:173], v71 offset:30752
    v_lshlrev_b32 v154, 16, v202
    v_mfma_f32_16x16x32_bf16 a[192:195], a[128:131], a[244:247], a[192:195]
    ds_read_b64_tr_b16 a[174:175], v71 offset:31520
    v_and_b32 v162, s48, v202
    v_lshlrev_b32 v170, 16, v203
    s_add_u32 s51, s51, 10944512
    v_mfma_f32_16x16x32_bf16 a[196:199], a[132:135], a[244:247], a[196:199]
    buffer_load_dwordx4 v77, s[72:75], s80 offen offset:2048 lds
    s_add_u32 s80, s80, 176128
    v_and_b32 v178, s48, v203
    v_lshlrev_b32 v155, 16, v204
    v_and_b32 v163, s48, v204
    v_lshlrev_b32 v171, 16, v205
    s_lshr_b32 s11, s18, 18
    v_and_b32 v179, s48, v205
    v_lshlrev_b32 v156, 16, v206
    v_and_b32 v164, s48, v206
    v_lshlrev_b32 v172, 16, v207
    v_and_b32 v180, s48, v207
    s_add_u32 m0, s47, 4096
    s_or_b32 s49, s59, s58
    buffer_load_dwordx4 v34, s[68:71], s49 offen offset:0  lds
    v_lshlrev_b32 v157, 16, v208
    v_and_b32 v165, s48, v208
    v_lshlrev_b32 v173, 16, v209
    v_and_b32 v181, s48, v209
    v_lshlrev_b32 v158, 16, v210
    v_and_b32 v166, s48, v210
    v_lshlrev_b32 v174, 16, v211
    v_and_b32 v182, s48, v211
    v_lshlrev_b32 v159, 16, v212
    buffer_load_dwordx4 v35, s[68:71], s49 offen offset:1024  lds
    s_add_u32 s59, s59, 128
    v_and_b32 v167, s48, v212
    v_lshlrev_b32 v175, 16, v213
    v_and_b32 v183, s48, v213
    v_lshlrev_b32 v160, 16, v214
    v_and_b32 v168, s48, v214
    v_lshlrev_b32 v176, 16, v215
    v_and_b32 v184, s48, v215
    v_lshlrev_b32 v161, 16, v216
    v_and_b32 v169, s48, v216
    buffer_load_dwordx4 v36, s[68:71], s49 offen offset:2048  lds
    s_and_b32 s59, s59, 0x3ff
    v_lshlrev_b32 v177, 16, v217
    v_and_b32 v185, s48, v217
    s_waitcnt lgkmcnt(4)
    v_lshlrev_b32 v186, 16, v226
    v_and_b32 v187, s48, v226
    v_lshlrev_b32 v188, 16, v227
    v_and_b32 v189, s48, v227
    v_lshlrev_b32 v190, 16, v228
    v_and_b32 v191, s48, v228
    v_lshlrev_b32 v192, 16, v229
    buffer_load_dwordx4 v37, s[68:71], s49 offen offset:3072  lds
    v_and_b32 v193, s48, v229
    v_lshlrev_b32 v194, 16, v230
    v_and_b32 v195, s48, v230
    v_lshlrev_b32 v196, 16, v231
    v_and_b32 v197, s48, v231
    v_lshlrev_b32 v198, 16, v232
    v_and_b32 v199, s48, v232
    v_lshlrev_b32 v200, 16, v233
    v_and_b32 v201, s48, v233
    s_add_u32 m0, s47, 8192
    s_or_b32 s49, s59, s58
    buffer_load_dwordx4 v34, s[68:71], s49 offen offset:0  lds
    v_lshlrev_b32 v202, 16, v234
    v_and_b32 v203, s48, v234
    v_lshlrev_b32 v204, 16, v235
    v_and_b32 v205, s48, v235
    v_lshlrev_b32 v206, 16, v236
    v_and_b32 v207, s48, v236
    v_lshlrev_b32 v208, 16, v237
    v_and_b32 v209, s48, v237
    v_lshlrev_b32 v210, 16, v238
    buffer_load_dwordx4 v35, s[68:71], s49 offen offset:1024  lds
    s_add_u32 s59, s59, 128
    v_and_b32 v211, s48, v238
    v_lshlrev_b32 v212, 16, v239
    v_and_b32 v213, s48, v239
    v_lshlrev_b32 v214, 16, v240
    v_and_b32 v215, s48, v240
    v_lshlrev_b32 v216, 16, v241
    v_and_b32 v217, s48, v241
    v_lshlrev_b32 v218, 16, v242
    v_and_b32 v219, s48, v242
    v_lshlrev_b32 v220, 16, v243
    buffer_load_dwordx4 v36, s[68:71], s49 offen offset:2048  lds
    s_and_b32 s59, s59, 0x3ff
    v_and_b32 v221, s48, v243
    v_lshlrev_b32 v222, 16, v244
    v_and_b32 v223, s48, v244
    v_lshlrev_b32 v224, 16, v245
    v_and_b32 v225, s48, v245
    v_pk_mul_f32 v[226:227], v[186:187], v[178:179]
    v_pk_mul_f32 v[228:229], v[188:189], v[180:181]
    v_pk_mul_f32 v[230:231], v[190:191], v[182:183]
    v_pk_mul_f32 v[232:233], v[192:193], v[184:185]
    buffer_load_dwordx4 v37, s[68:71], s49 offen offset:3072  lds
    v_pk_fma_f32 v[226:227], v[194:195], v[170:171], v[226:227]
    v_pk_fma_f32 v[228:229], v[196:197], v[172:173], v[228:229]
    v_pk_fma_f32 v[230:231], v[198:199], v[174:175], v[230:231]
    v_pk_fma_f32 v[232:233], v[200:201], v[176:177], v[232:233]
    v_pk_fma_f32 v[226:227], v[202:203], v[162:163], v[226:227]
    v_pk_fma_f32 v[228:229], v[204:205], v[164:165], v[228:229]
    v_pk_fma_f32 v[230:231], v[206:207], v[166:167], v[230:231]
    v_pk_fma_f32 v[232:233], v[208:209], v[168:169], v[232:233]
    v_pk_fma_f32 v[226:227], v[210:211], v[154:155], v[226:227]
    global_load_dword v97, v97, s[24:25]
    v_pk_fma_f32 v[228:229], v[212:213], v[156:157], v[228:229]
    v_pk_fma_f32 v[230:231], v[214:215], v[158:159], v[230:231]
    v_pk_fma_f32 v[232:233], v[216:217], v[160:161], v[232:233]
    v_pk_mul_f32 v[234:235], v[194:195], v[178:179]
    v_pk_mul_f32 v[236:237], v[196:197], v[180:181]
    v_pk_mul_f32 v[238:239], v[198:199], v[182:183]
    v_pk_mul_f32 v[240:241], v[200:201], v[184:185]
    v_pk_fma_f32 v[234:235], v[202:203], v[170:171], v[234:235]
    v_pk_fma_f32 v[236:237], v[204:205], v[172:173], v[236:237]
    v_pk_fma_f32 v[238:239], v[206:207], v[174:175], v[238:239]
    global_load_dword v98, v98, s[28:29]
    v_pk_fma_f32 v[240:241], v[208:209], v[176:177], v[240:241]
    v_pk_fma_f32 v[234:235], v[210:211], v[162:163], v[234:235]
    v_pk_fma_f32 v[236:237], v[212:213], v[164:165], v[236:237]
    v_pk_fma_f32 v[238:239], v[214:215], v[166:167], v[238:239]
    v_pk_fma_f32 v[240:241], v[216:217], v[168:169], v[240:241]
    v_pk_fma_f32 v[234:235], v[218:219], v[154:155], v[234:235]
    v_pk_fma_f32 v[236:237], v[220:221], v[156:157], v[236:237]
    v_pk_fma_f32 v[238:239], v[222:223], v[158:159], v[238:239]
    v_pk_fma_f32 v[240:241], v[224:225], v[160:161], v[240:241]
    s_mov_b64 exec, 1
    buffer_load_dwordx2 a[228:229], v96, s[60:63], 0 offen
    s_mov_b64 exec, -1
    v_lshlrev_b32 v154, 16, v246
    v_and_b32 v155, s48, v246
    v_lshlrev_b32 v156, 16, v247
    v_and_b32 v157, s48, v247
    v_lshlrev_b32 v158, 16, v248
    v_and_b32 v159, s48, v248
    v_lshlrev_b32 v160, 16, v249
    v_and_b32 v161, s48, v249
    v_lshlrev_b32 v162, 16, v250
    buffer_load_dwordx4 a[230:233], v81, s[60:63], 0 offen nt
    v_and_b32 v163, s48, v250
    v_lshlrev_b32 v164, 16, v251
    v_and_b32 v165, s48, v251
    v_lshlrev_b32 v166, 16, v252
    v_and_b32 v167, s48, v252
    v_lshlrev_b32 v168, 16, v253
    v_and_b32 v169, s48, v253
    v_pk_mul_f32 v[226:227], v[226:227], v[154:155]
    v_pk_mul_f32 v[228:229], v[228:229], v[156:157]
    v_pk_mul_f32 v[230:231], v[230:231], v[158:159]
    buffer_load_dwordx4 a[236:239], v81, s[60:63], 0 offen offset:1024 nt
    v_pk_mul_f32 v[232:233], v[232:233], v[160:161]
    v_pk_mul_f32 v[234:235], v[234:235], v[162:163]
    v_pk_mul_f32 v[236:237], v[236:237], v[164:165]
    v_pk_mul_f32 v[238:239], v[238:239], v[166:167]
    v_pk_mul_f32 v[240:241], v[240:241], v[168:169]
    v_cvt_pk_bf16_f32 v246, v234, v226
    ds_write_b32 v99, v246 offset:0
    v_cvt_pk_bf16_f32 v247, v235, v227
    ds_write_b32 v99, v247 offset:128
    s_lshl_b32 s3, s2, 2
    s_add_u32 s3, s3, s36
    s_mul_i32 s3, s3, 1408
    v_lshlrev_b32 v29, 3, v11
    s_mov_b64 exec, 0x7ff
    buffer_load_dword v29, v29, s[64:67], s3 offen
    s_mov_b64 exec, -1
    v_cvt_pk_bf16_f32 v248, v236, v228
    ds_write_b32 v99, v248 offset:256
    v_cvt_pk_bf16_f32 v249, v237, v229
    ds_write_b32 v99, v249 offset:384
    v_cvt_pk_bf16_f32 v250, v238, v230
    ds_write_b32 v99, v250 offset:512
    v_cvt_pk_bf16_f32 v251, v239, v231
    ds_write_b32 v99, v251 offset:640
    v_cvt_pk_bf16_f32 v252, v240, v232
    ds_write_b32 v99, v252 offset:768
    v_cvt_pk_bf16_f32 v253, v241, v233
    ds_write_b32 v99, v253 offset:896
    s_lshl_b32 s11, s11, 1
    s_waitcnt vmcnt(18) lgkmcnt(0)
    s_barrier
    ds_read_b64_tr_b16 a[128:129], v66 offset:36864
    s_add_u32 s11, s11, s8
    v_mfma_f32_16x16x32_bf16 v[106:109], a[152:155], a[104:107], v[106:109]
    ds_read_b128 v[246:249], v100
    ds_read_b128 v[250:253], v100 offset:1040
    v_mfma_f32_16x16x32_bf16 v[110:113], a[152:155], a[108:111], v[110:113]
    ds_read_b64_tr_b16 a[130:131], v66 offset:37632
    s_mul_i32 s52, s11, 4352
    v_mfma_f32_16x16x32_bf16 v[114:117], a[156:159], a[104:107], v[114:117]
    ds_read_b64_tr_b16 a[132:133], v67 offset:36896
    ds_read_b128 a[112:115], v64 offset:0
    s_waitcnt lgkmcnt(4)
    buffer_store_dwordx4 v[246:249], v101, s[76:79], s23 offen sc1
    s_add_u32 s23, s23, 34816
    v_mfma_f32_16x16x32_bf16 v[118:121], a[156:159], a[108:111], v[118:121]
    ds_read_b64_tr_b16 a[134:135], v67 offset:37664
    ds_read_b128 a[116:119], v64 offset:2048
    v_mfma_f32_16x16x32_bf16 v[122:125], a[160:163], a[104:107], v[122:125]
    ds_read_b64_tr_b16 a[136:137], v68 offset:36864
    ds_read_b128 a[120:123], v65 offset:0
    s_waitcnt lgkmcnt(7)
    buffer_store_dwordx4 v[250:253], v101, s[76:79], s23 offen sc1
    s_lshr_b32 s11, s18, 12
    v_mfma_f32_16x16x32_bf16 v[126:129], a[160:163], a[108:111], v[126:129]
    ds_read_b64_tr_b16 a[138:139], v68 offset:37632
    ds_read_b128 a[124:127], v65 offset:2048
    s_and_b32 s11, s11, 63
    v_mfma_f32_16x16x32_bf16 v[130:133], a[164:167], a[104:107], v[130:133]
    ds_read_b64_tr_b16 a[140:141], v69 offset:36896
    s_lshl_b32 s11, s11, 6
    v_mfma_f32_16x16x32_bf16 v[134:137], a[164:167], a[108:111], v[134:137]
    s_add_u32 m0, s57, 24576
    s_cmp_ge_u32 s80, s81
    s_cselect_b32 s5, 1409024, 0
    s_sub_u32 s80, s80, s5
    buffer_load_dwordx4 v75, s[72:75], s80 offen offset:0 lds
    v_mfma_f32_16x16x32_bf16 v[138:141], a[168:171], a[104:107], v[138:141]
    ds_read_b64_tr_b16 a[142:143], v69 offset:37664
    s_add_u32 s52, s52, s11
    v_mfma_f32_16x16x32_bf16 v[142:145], a[168:171], a[108:111], v[142:145]
    ds_read_b64_tr_b16 a[144:145], v70 offset:36864
    buffer_load_dwordx4 v76, s[72:75], s80 offen offset:1024 lds
    v_mfma_f32_16x16x32_bf16 v[146:149], a[172:175], a[104:107], v[146:149]
    ds_read_b64_tr_b16 a[146:147], v70 offset:37632
    s_add_u32 s52, s52, 11141120
    v_mfma_f32_16x16x32_bf16 v[150:153], a[172:175], a[108:111], v[150:153]
    ds_read_b64_tr_b16 a[148:149], v71 offset:36896
    v_mfma_f32_16x16x32_bf16 a[192:195], a[152:155], a[244:247], a[192:195]
    ds_read_b64_tr_b16 a[150:151], v71 offset:37664
    buffer_load_dwordx4 v77, s[72:75], s80 offen offset:2048 lds
    s_add_u32 s80, s80, 176128
    v_lshlrev_b32 v4, 3, v1
    v_mfma_f32_16x16x32_bf16 a[196:199], a[156:159], a[244:247], a[196:199]
    v_add_u32 v18, s47, v4
    s_waitcnt lgkmcnt(6)
    v_mfma_f32_16x16x32_bf16 v[106:109], a[128:131], a[112:115], v[106:109]
    ds_read_b64_tr_b16 a[152:153], v66 offset:43008
    s_mul_i32 s11, s4, 2304
    v_mfma_f32_16x16x32_bf16 v[110:113], a[128:131], a[116:119], v[110:113]
    ds_read_b64_tr_b16 a[154:155], v66 offset:43776
    s_add_u32 s11, s11, 10747904
    v_mfma_f32_16x16x32_bf16 v[114:117], a[132:135], a[112:115], v[114:117]
    ds_read_b64_tr_b16 a[156:157], v67 offset:43040
    v_mfma_f32_16x16x32_bf16 v[118:121], a[132:135], a[116:119], v[118:121]
    s_add_u32 m0, s47, 0
    s_or_b32 s49, s59, s58
    buffer_load_dwordx4 v34, s[68:71], s49 offen offset:0  lds
    v_mfma_f32_16x16x32_bf16 v[122:125], a[136:139], a[112:115], v[122:125]
    ds_read_b64_tr_b16 a[158:159], v67 offset:43808
    v_lshrrev_b32 v19, 1, v1
    v_mfma_f32_16x16x32_bf16 v[126:129], a[136:139], a[116:119], v[126:129]
    ds_read_b64_tr_b16 a[160:161], v68 offset:43008
    s_waitcnt lgkmcnt(9)
    v_mfma_f32_16x16x32_bf16 v[130:133], a[140:143], a[112:115], v[130:133]
    ds_read_b64_tr_b16 a[162:163], v68 offset:43776
    buffer_load_dwordx4 v35, s[68:71], s49 offen offset:1024  lds
    s_add_u32 s59, s59, 128
    v_lshl_add_u32 v19, v19, 6, s11
    v_mfma_f32_16x16x32_bf16 v[134:137], a[140:143], a[116:119], v[134:137]
    ds_read_b64_tr_b16 a[164:165], v69 offset:43040
    s_lshr_b32 s11, s39, 4
    s_waitcnt lgkmcnt(9)
    v_mfma_f32_16x16x32_bf16 v[138:141], a[144:147], a[112:115], v[138:141]
    ds_read_b64_tr_b16 a[166:167], v69 offset:43808
    s_lshl_b32 s12, s40, 1
    v_mfma_f32_16x16x32_bf16 v[142:145], a[144:147], a[116:119], v[142:145]
    ds_read_b64_tr_b16 a[168:169], v70 offset:43008
    buffer_load_dwordx4 v36, s[68:71], s49 offen offset:2048  lds
    s_and_b32 s59, s59, 0x3ff
    s_waitcnt lgkmcnt(9)
    v_mfma_f32_16x16x32_bf16 v[146:149], a[148:151], a[112:115], v[146:149]
    ds_read_b64_tr_b16 a[170:171], v70 offset:43776
    s_add_u32 s11, s11, s12
    v_mfma_f32_16x16x32_bf16 v[150:153], a[148:151], a[116:119], v[150:153]
    ds_read_b64_tr_b16 a[172:173], v71 offset:43040
    s_mul_i32 s11, s11, 4352
    v_mfma_f32_16x16x32_bf16 a[192:195], a[128:131], a[244:247], a[192:195]
    ds_read_b64_tr_b16 a[174:175], v71 offset:43808
    buffer_load_dwordx4 v37, s[68:71], s49 offen offset:3072  lds
    v_mfma_f32_16x16x32_bf16 a[196:199], a[132:135], a[244:247], a[196:199]
    s_add_u32 s11, s11, 11141120
    s_waitcnt lgkmcnt(10)
    v_mfma_f32_16x16x32_bf16 v[106:109], a[152:155], a[120:123], v[106:109]
    ds_read_b64_tr_b16 a[128:129], v66 offset:0
    s_waitcnt vmcnt(19)
    s_waitcnt vmcnt(13)
    v_mfma_f32_16x16x32_bf16 v[110:113], a[152:155], a[124:127], v[110:113]
    v_lshl_add_u32 v21, v1, 6, s11
    s_waitcnt lgkmcnt(9)
    v_mfma_f32_16x16x32_bf16 v[114:117], a[156:159], a[120:123], v[114:117]
    ds_read_b64_tr_b16 a[130:131], v66 offset:768
    ds_read_b128 a[64:67], v64 offset:4096
    v_lshlrev_b32 v190, 16, v97
    v_mfma_f32_16x16x32_bf16 v[118:121], a[156:159], a[124:127], v[118:121]
    ds_read_b64_tr_b16 a[132:133], v67 offset:32
    ds_read_b128 a[68:71], v64 offset:6144
    v_min_u32 v20, 9, v1
    s_waitcnt lgkmcnt(11)
    v_mfma_f32_16x16x32_bf16 v[122:125], a[160:163], a[120:123], v[122:125]
    ds_read_b64_tr_b16 a[134:135], v67 offset:800
    ds_read_b128 a[72:75], v65 offset:4096
    v_and_b32 v191, s48, v97
    s_lshl_b32 s11, s36, 3
    v_mfma_f32_16x16x32_bf16 v[126:129], a[160:163], a[124:127], v[126:129]
    ds_read_b64_tr_b16 a[136:137], v68 offset:0
    ds_read_b128 a[76:79], v65 offset:6144
    s_waitcnt lgkmcnt(13)
    v_mfma_f32_16x16x32_bf16 v[130:133], a[164:167], a[120:123], v[130:133]
    ds_read_b64_tr_b16 a[138:139], v68 offset:768
    v_lshlrev_b32 v192, 16, v98
    v_add_u32 v20, s11, v20
    v_mfma_f32_16x16x32_bf16 v[134:137], a[164:167], a[124:127], v[134:137]
    ds_read_b64_tr_b16 a[140:141], v69 offset:32
    s_waitcnt lgkmcnt(13)
    v_mfma_f32_16x16x32_bf16 v[138:141], a[168:171], a[120:123], v[138:141]
    ds_read_b64_tr_b16 a[142:143], v69 offset:800
    v_and_b32 v193, s48, v98
    v_min_u32 v20, 31, v20
    v_mfma_f32_16x16x32_bf16 v[142:145], a[168:171], a[124:127], v[142:145]
    ds_read_b64_tr_b16 a[144:145], v70 offset:0
    s_mul_i32 s11, s39, 2304
    s_waitcnt lgkmcnt(13)
    v_mfma_f32_16x16x32_bf16 v[146:149], a[172:175], a[120:123], v[146:149]
    ds_read_b64_tr_b16 a[146:147], v70 offset:768
    ds_write_b64 v104, v[190:191]
    v_mfma_f32_16x16x32_bf16 v[150:153], a[172:175], a[124:127], v[150:153]
    ds_read_b64_tr_b16 a[148:149], v71 offset:32
    s_add_u32 s11, s11, 10944512
    v_mfma_f32_16x16x32_bf16 a[192:195], a[152:155], a[244:247], a[192:195]
    ds_read_b64_tr_b16 a[150:151], v71 offset:800
    s_waitcnt vmcnt(7)
    s_mov_b64 exec, 15
    buffer_store_dwordx4 v[30:33], v11, s[76:79], s50 offen sc1
    s_mov_b64 exec, -1
    ds_write_b64 v105, v[192:193]
    v_lshl_add_u32 v20, v20, 6, s11
    v_mfma_f32_16x16x32_bf16 a[196:199], a[156:159], a[244:247], a[196:199]
    v_and_b32 v2, 3, v1
    s_waitcnt lgkmcnt(9)
    v_mfma_f32_16x16x32_bf16 v[106:109], a[128:131], a[64:67], v[106:109]
    ds_read_b64_tr_b16 a[152:153], v66 offset:6144
    v_mfma_f32_16x16x32_bf16 v[110:113], a[128:131], a[68:71], v[110:113]
    ds_read_b64_tr_b16 a[154:155], v66 offset:6912
    v_mfma_f32_16x16x32_bf16 v[114:117], a[132:135], a[64:67], v[114:117]
    ds_read_b64_tr_b16 a[156:157], v67 offset:6176
    v_mul_u32_u24 v13, 4160, v2
    v_mfma_f32_16x16x32_bf16 v[118:121], a[132:135], a[68:71], v[118:121]
    ds_read_b64_tr_b16 a[158:159], v67 offset:6944
    s_add_u32 m0, s47, 4096
    s_or_b32 s49, s59, s58
    buffer_load_dwordx4 v34, s[68:71], s49 offen offset:0  lds
    v_lshrrev_b32 v3, 2, v9
    s_waitcnt lgkmcnt(12)
    v_mfma_f32_16x16x32_bf16 v[122:125], a[136:139], a[64:67], v[122:125]
    ds_read_b64_tr_b16 a[160:161], v68 offset:6144
    v_add_u32 v3, v3, v10
    v_mfma_f32_16x16x32_bf16 v[126:129], a[136:139], a[68:71], v[126:129]
    ds_read_b64_tr_b16 a[162:163], v68 offset:6912
    s_waitcnt lgkmcnt(12)
    v_mfma_f32_16x16x32_bf16 v[130:133], a[140:143], a[64:67], v[130:133]
    ds_read_b64_tr_b16 a[164:165], v69 offset:6176
    ds_read_b64_tr_b16 a[166:167], v69 offset:6944
    buffer_load_dwordx4 v35, s[68:71], s49 offen offset:1024  lds
    s_add_u32 s59, s59, 128
    v_lshl_add_u32 v13, v3, 4, v13
    v_mfma_f32_16x16x32_bf16 v[134:137], a[140:143], a[68:71], v[134:137]
    ds_read_b64_tr_b16 a[168:169], v70 offset:6144
    s_lshl_b32 s13, s8, 8
    s_waitcnt lgkmcnt(13)
    v_mfma_f32_16x16x32_bf16 v[138:141], a[144:147], a[64:67], v[138:141]
    ds_read_b64_tr_b16 a[170:171], v70 offset:6912
    v_mfma_f32_16x16x32_bf16 v[142:145], a[144:147], a[68:71], v[142:145]
    ds_read_b64_tr_b16 a[172:173], v71 offset:6176
    ds_read_b64_tr_b16 a[174:175], v71 offset:6944
    s_waitcnt lgkmcnt(13)
    v_mfma_f32_16x16x32_bf16 v[146:149], a[148:151], a[64:67], v[146:149]
    buffer_load_dwordx4 v36, s[68:71], s49 offen offset:2048  lds
    s_and_b32 s59, s59, 0x3ff
    s_mul_i32 s11, s9, 16640
    s_add_u32 s12, s13, s11
    v_mfma_f32_16x16x32_bf16 v[150:153], a[148:151], a[68:71], v[150:153]
    buffer_load_dwordx4 v37, s[68:71], s49 offen offset:3072  lds
    v_mfma_f32_16x16x32_bf16 a[192:195], a[128:131], a[244:247], a[192:195]
    v_add_u32 v13, s12, v13
    v_mfma_f32_16x16x32_bf16 a[196:199], a[132:135], a[244:247], a[196:199]
    v_and_b32 v4, 1, v1
    s_waitcnt vmcnt(9) lgkmcnt(0)
    s_barrier
    ds_read_b64_tr_b16 a[128:129], v66 offset:12288
    v_mfma_f32_16x16x32_bf16 v[106:109], a[152:155], a[72:75], v[106:109]
    ds_read_b64_tr_b16 a[130:131], v66 offset:13056
    v_mfma_f32_16x16x32_bf16 v[110:113], a[152:155], a[76:79], v[110:113]
    v_mul_u32_u24 v14, 4576, v4
    v_mfma_f32_16x16x32_bf16 v[114:117], a[156:159], a[72:75], v[114:117]
    ds_read_b64_tr_b16 a[132:133], v67 offset:12320
    ds_read_b128 a[80:83], v64 offset:8192
    v_accvgpr_read_b32 v158, a232
    v_mfma_f32_16x16x32_bf16 v[118:121], a[156:159], a[76:79], v[118:121]
    ds_read_b64_tr_b16 a[134:135], v67 offset:13088
    ds_read_b128 a[84:87], v64 offset:10240
    s_add_u32 m0, s57, 36864
    s_cmp_ge_u32 s80, s81
    s_cselect_b32 s5, 1409024, 0
    s_sub_u32 s80, s80, s5
    buffer_load_dwordx4 v75, s[72:75], s80 offen offset:0 lds
    v_accvgpr_read_b32 v159, a233
    v_lshrrev_b32 v5, 1, v9
    v_mfma_f32_16x16x32_bf16 v[122:125], a[160:163], a[72:75], v[122:125]
    ds_read_b64_tr_b16 a[136:137], v68 offset:12288
    ds_read_b128 a[88:91], v65 offset:8192
    v_lshlrev_b32 v5, 2, v5
    v_mfma_f32_16x16x32_bf16 v[126:129], a[160:163], a[76:79], v[126:129]
    ds_read_b64_tr_b16 a[138:139], v68 offset:13056
    ds_read_b128 a[92:95], v65 offset:10240
    v_accvgpr_read_b32 v154, a228
    v_mfma_f32_16x16x32_bf16 v[130:133], a[164:167], a[72:75], v[130:133]
    buffer_load_dwordx4 v76, s[72:75], s80 offen offset:1024 lds
    v_accvgpr_read_b32 v155, a229
    v_sub_u32 v5, v10, v5
    v_mfma_f32_16x16x32_bf16 v[134:137], a[164:167], a[76:79], v[134:137]
    ds_read_b64_tr_b16 a[140:141], v69 offset:12320
    v_accvgpr_read_b32 v164, a238
    v_add_u32 v5, 28, v5
    v_mfma_f32_16x16x32_bf16 v[138:141], a[168:171], a[72:75], v[138:141]
    ds_read_b64_tr_b16 a[142:143], v69 offset:13088
    v_accvgpr_read_b32 v165, a239
    v_mfma_f32_16x16x32_bf16 v[142:145], a[168:171], a[76:79], v[142:145]
    ds_read_b64_tr_b16 a[144:145], v70 offset:12288
    buffer_load_dwordx4 v77, s[72:75], s80 offen offset:2048 lds
    s_add_u32 s80, s80, 176128
    v_lshl_add_u32 v14, v5, 4, v14
    v_mfma_f32_16x16x32_bf16 v[146:149], a[172:175], a[72:75], v[146:149]
    ds_read_b64_tr_b16 a[146:147], v70 offset:13056
    v_accvgpr_read_b32 v156, a230
    s_mul_i32 s12, s9, 9152
    v_mfma_f32_16x16x32_bf16 v[150:153], a[172:175], a[76:79], v[150:153]
    ds_read_b64_tr_b16 a[148:149], v71 offset:12320
    v_accvgpr_read_b32 v157, a231
    v_mfma_f32_16x16x32_bf16 a[192:195], a[152:155], a[244:247], a[192:195]
    ds_read_b64_tr_b16 a[150:151], v71 offset:13088
    buffer_load_dwordx4 v[246:249], v26, s[76:79], 0 offen sc1
    s_add_u32 s12, s12, s13
    v_mfma_f32_16x16x32_bf16 a[196:199], a[156:159], a[244:247], a[196:199]
    v_accvgpr_read_b32 v162, a236
    s_add_u32 s12, s12, 66048
    s_waitcnt lgkmcnt(6)
    v_mfma_f32_16x16x32_bf16 v[106:109], a[128:131], a[80:83], v[106:109]
    v_accvgpr_read_b32 v163, a237
    ds_read_b64_tr_b16 a[152:153], v66 offset:18432
    v_mfma_f32_16x16x32_bf16 v[110:113], a[128:131], a[84:87], v[110:113]
    v_add_u32 v14, s12, v14
    v_mfma_f32_16x16x32_bf16 v[114:117], a[132:135], a[80:83], v[114:117]
    ds_read_b64_tr_b16 a[154:155], v66 offset:19200
    v_mov_b32_dpp v160, v158 wave_ror:1 row_mask:0xf bank_mask:0xf
    v_mfma_f32_16x16x32_bf16 v[118:121], a[132:135], a[84:87], v[118:121]
    ds_read_b64_tr_b16 a[156:157], v67 offset:18464
    s_add_u32 m0, s32, 33280
    s_nop 0
    buffer_load_dwordx4 v38, s[64:67], s33 offen offset:0 lds
    v_mov_b32_dpp v161, v159 wave_ror:1 row_mask:0xf bank_mask:0xf
    s_lshl_b32 s12, s9, 4
    v_mfma_f32_16x16x32_bf16 v[122:125], a[136:139], a[80:83], v[122:125]
    ds_read_b64_tr_b16 a[158:159], v67 offset:19232
    v_mov_b32_dpp v154, v158 wave_shr:1 row_mask:0xf bank_mask:0xf
    s_lshr_b32 s82, s82, s12
    v_mfma_f32_16x16x32_bf16 v[126:129], a[136:139], a[84:87], v[126:129]
    ds_read_b64_tr_b16 a[160:161], v68 offset:18432
    s_and_b32 s82, s82, 0xffff
    s_waitcnt lgkmcnt(9)
    v_mfma_f32_16x16x32_bf16 v[130:133], a[140:143], a[80:83], v[130:133]
    ds_read_b64_tr_b16 a[162:163], v68 offset:19200
    buffer_load_dwordx4 v39, s[64:67], s33 offen offset:1024 lds
    v_mov_b32_dpp v155, v159 wave_shr:1 row_mask:0xf bank_mask:0xf
    v_mfma_f32_16x16x32_bf16 v[134:137], a[140:143], a[84:87], v[134:137]
    ds_read_b64_tr_b16 a[164:165], v69 offset:18464
    v_mov_b32_dpp v160, v164 wave_shr:1 row_mask:0xf bank_mask:0xf
    s_waitcnt lgkmcnt(9)
    v_mfma_f32_16x16x32_bf16 v[138:141], a[144:147], a[80:83], v[138:141]
    ds_read_b64_tr_b16 a[166:167], v69 offset:19232
    v_mov_b32_dpp v161, v165 wave_shr:1 row_mask:0xf bank_mask:0xf
    s_cmp_eq_u32 s8, 0
    s_cselect_b32 s82, s82, 0
    v_mfma_f32_16x16x32_bf16 v[142:145], a[144:147], a[84:87], v[142:145]
    ds_read_b64_tr_b16 a[168:169], v70 offset:18432
    buffer_load_dwordx4 v40, s[64:67], s33 offen offset:2048 lds
    v_xor_b32 v4, 1, v4
    s_waitcnt lgkmcnt(9)
    v_mfma_f32_16x16x32_bf16 v[146:149], a[148:151], a[80:83], v[146:149]
    ds_read_b64_tr_b16 a[170:171], v70 offset:19200
    v_alignbit_b32 v166, v155, v154, 16
    v_mfma_f32_16x16x32_bf16 v[150:153], a[148:151], a[84:87], v[150:153]
    ds_read_b64_tr_b16 a[172:173], v71 offset:18464
    v_alignbit_b32 v167, v156, v155, 16
    v_lshlrev_b32 v4, 4, v4
    v_mfma_f32_16x16x32_bf16 a[192:195], a[128:131], a[244:247], a[192:195]
    ds_read_b64_tr_b16 a[174:175], v71 offset:19232
    buffer_load_dwordx4 v41, s[64:67], s33 offen offset:3072 lds
    v_alignbit_b32 v168, v157, v156, 16
    v_lshlrev_b32_e64 v4, v4, s82
    v_mfma_f32_16x16x32_bf16 a[196:199], a[132:135], a[244:247], a[196:199]
    v_alignbit_b32 v169, v158, v157, 16
    s_waitcnt lgkmcnt(10)
    v_mfma_f32_16x16x32_bf16 v[106:109], a[152:155], a[88:91], v[106:109]
    v_cmp_eq_u32 vcc, 3, v3
    s_nop 1
    v_cndmask_b32 v4, 0, v4, vcc
    v_mfma_f32_16x16x32_bf16 v[110:113], a[152:155], a[92:95], v[110:113]
    ds_read_b64_tr_b16 a[128:129], v66 offset:24576
    s_waitcnt vmcnt(13)
    v_alignbit_b32 v170, v156, v155, 16
    s_waitcnt lgkmcnt(9)
    v_mfma_f32_16x16x32_bf16 v[114:117], a[156:159], a[88:91], v[114:117]
    ds_read_b64_tr_b16 a[130:131], v66 offset:25344
    ds_read_b128 a[96:99], v64 offset:0
    v_cmp_lt_u32 vcc, 1, v2
    s_nop 1
    v_cndmask_b32 v5, 0, v4, vcc
    v_mfma_f32_16x16x32_bf16 v[118:121], a[156:159], a[92:95], v[118:121]
    ds_read_b64_tr_b16 a[132:133], v67 offset:24608
    ds_read_b128 a[100:103], v64 offset:2048
    s_add_u32 m0, s47, 8192
    s_nop 0
    buffer_load_dwordx4 v38, s[64:67], s34 offen offset:0 lds
    v_alignbit_b32 v171, v157, v156, 16
    v_sub_u32 v4, v4, v5
    s_waitcnt lgkmcnt(11)
    v_mfma_f32_16x16x32_bf16 v[122:125], a[160:163], a[88:91], v[122:125]
    ds_read_b64_tr_b16 a[134:135], v67 offset:25376
    ds_read_b128 a[104:107], v65 offset:0
    v_alignbit_b32 v172, v158, v157, 16
    v_mfma_f32_16x16x32_bf16 v[126:129], a[160:163], a[92:95], v[126:129]
    ds_read_b64_tr_b16 a[136:137], v68 offset:24576
    ds_read_b128 a[108:111], v65 offset:2048
    v_alignbit_b32 v173, v159, v158, 16
    v_accvgpr_write_b32 a240, v5
    s_waitcnt lgkmcnt(13)
    v_mfma_f32_16x16x32_bf16 v[130:133], a[164:167], a[88:91], v[130:133]
    ds_read_b64_tr_b16 a[138:139], v68 offset:25344
    buffer_load_dwordx4 v39, s[64:67], s34 offen offset:1024 lds
    v_accvgpr_write_b32 a241, v4
    v_mfma_f32_16x16x32_bf16 v[134:137], a[164:167], a[92:95], v[134:137]
    ds_read_b64_tr_b16 a[140:141], v69 offset:24608
    v_mov_b32 v174, v155
    s_waitcnt lgkmcnt(13)
    v_mfma_f32_16x16x32_bf16 v[138:141], a[168:171], a[88:91], v[138:141]
    ds_read_b64_tr_b16 a[142:143], v69 offset:25376
    v_mov_b32 v175, v156
    v_accvgpr_write_b32 a242, 0
    v_mfma_f32_16x16x32_bf16 v[142:145], a[168:171], a[92:95], v[142:145]
    ds_read_b64_tr_b16 a[144:145], v70 offset:24576
    buffer_load_dwordx4 v40, s[64:67], s34 offen offset:2048 lds
    v_mov_b32 v176, v157
    s_waitcnt lgkmcnt(13)
    v_mfma_f32_16x16x32_bf16 v[146:149], a[172:175], a[88:91], v[146:149]
    ds_read_b64_tr_b16 a[146:147], v70 offset:25344
    v_accvgpr_write_b32 a243, 0
    v_mfma_f32_16x16x32_bf16 v[150:153], a[172:175], a[92:95], v[150:153]
    ds_read_b64_tr_b16 a[148:149], v71 offset:24608
    v_mov_b32 v177, v158
    s_add_u32 s12, s11, 48
    v_mfma_f32_16x16x32_bf16 a[192:195], a[152:155], a[244:247], a[192:195]
    ds_read_b64_tr_b16 a[150:151], v71 offset:25376
    buffer_load_dwordx4 v41, s[64:67], s34 offen offset:3072 lds
    v_alignbit_b32 v178, v161, v160, 16
    v_mfma_f32_16x16x32_bf16 a[196:199], a[156:159], a[244:247], a[196:199]
    v_alignbit_b32 v179, v162, v161, 16
    v_add_u32 v24, s12, v81
    s_waitcnt lgkmcnt(7)
    v_mfma_f32_16x16x32_bf16 v[106:109], a[128:131], a[96:99], v[106:109]
    s_mul_i32 s55, s36, 4576
    ds_read_b64_tr_b16 a[152:153], v66 offset:30720
    v_mfma_f32_16x16x32_bf16 v[110:113], a[128:131], a[100:103], v[110:113]
    v_alignbit_b32 v180, v163, v162, 16
    s_add_u32 s55, s55, 66048
    v_mfma_f32_16x16x32_bf16 v[114:117], a[132:135], a[96:99], v[114:117]
    ds_read_b64_tr_b16 a[154:155], v66 offset:31488
    v_alignbit_b32 v181, v164, v163, 16
    v_mfma_f32_16x16x32_bf16 v[118:121], a[132:135], a[100:103], v[118:121]
    ds_read_b64_tr_b16 a[156:157], v67 offset:30752
    s_add_u32 m0, s47, 0
    s_nop 0
    buffer_load_dwordx4 v38, s[64:67], s35 offen offset:0 lds
    s_waitcnt lgkmcnt(9)
    v_mfma_f32_16x16x32_bf16 v[122:125], a[136:139], a[96:99], v[122:125]
    ds_read_b64_tr_b16 a[158:159], v67 offset:31520
    v_alignbit_b32 v182, v162, v161, 16
    s_lshl_b32 s12, s8, 3
    v_mfma_f32_16x16x32_bf16 v[126:129], a[136:139], a[100:103], v[126:129]
    ds_read_b64_tr_b16 a[160:161], v68 offset:30720
    v_alignbit_b32 v183, v163, v162, 16
    s_sub_u32 s56, 8, s12
    s_waitcnt lgkmcnt(9)
    v_mfma_f32_16x16x32_bf16 v[130:133], a[140:143], a[96:99], v[130:133]
    ds_read_b64_tr_b16 a[162:163], v68 offset:31488
    buffer_load_dwordx4 v39, s[64:67], s35 offen offset:1024 lds
    v_alignbit_b32 v184, v164, v163, 16
    v_mfma_f32_16x16x32_bf16 v[134:137], a[140:143], a[100:103], v[134:137]
    ds_read_b64_tr_b16 a[164:165], v69 offset:30752
    s_add_u32 s13, s55, 4096
    s_waitcnt lgkmcnt(9)
    v_mfma_f32_16x16x32_bf16 v[138:141], a[144:147], a[96:99], v[138:141]
    ds_read_b64_tr_b16 a[166:167], v69 offset:31520
    v_alignbit_b32 v185, v165, v164, 16
    v_add_u32 v25, s13, v11
    v_mfma_f32_16x16x32_bf16 v[142:145], a[144:147], a[100:103], v[142:145]
    ds_read_b64_tr_b16 a[168:169], v70 offset:30720
    v_mov_b32 v186, v161
    s_waitcnt lgkmcnt(9)
    v_mfma_f32_16x16x32_bf16 v[146:149], a[148:151], a[96:99], v[146:149]
    ds_read_b64_tr_b16 a[170:171], v70 offset:31488
    buffer_load_dwordx4 v40, s[64:67], s35 offen offset:2048 lds
    v_mov_b32 v187, v162
    v_subrev_u32 v2, 28, v1
    v_mfma_f32_16x16x32_bf16 v[150:153], a[148:151], a[100:103], v[150:153]
    ds_read_b64_tr_b16 a[172:173], v71 offset:30752
    v_mfma_f32_16x16x32_bf16 a[192:195], a[128:131], a[244:247], a[192:195]
    ds_read_b64_tr_b16 a[174:175], v71 offset:31520
    v_mov_b32 v188, v163
    v_min_u32 v2, 5, v2
    v_mfma_f32_16x16x32_bf16 a[196:199], a[132:135], a[244:247], a[196:199]
    buffer_load_dwordx4 v41, s[64:67], s35 offen offset:3072 lds
    v_mov_b32 v189, v164
    v_cmp_lt_u32 vcc, 2, v2
    v_lshlrev_b32 v2, 4, v2
    v_add_u32 v3, 4112, v2
    v_cndmask_b32 v2, v2, v3, vcc
    s_waitcnt vmcnt(13)
    s_barrier
    ds_read_b64_tr_b16 a[128:129], v66 offset:36864
    s_mul_i32 s12, s36, 8320
    s_waitcnt lgkmcnt(11)
    v_mfma_f32_16x16x32_bf16 v[106:109], a[152:155], a[104:107], v[106:109]
    ds_read_b64_tr_b16 a[130:131], v66 offset:37632
    v_mfma_f32_16x16x32_bf16 v[110:113], a[152:155], a[108:111], v[110:113]
    v_add_u32 v2, s12, v2
    s_waitcnt lgkmcnt(10)
    v_mfma_f32_16x16x32_bf16 v[114:117], a[156:159], a[104:107], v[114:117]
    ds_read_b64_tr_b16 a[132:133], v67 offset:36896
    ds_read_b128 a[112:115], v64 offset:4096
    ds_read_b128 v[198:201], v72 offset:1408
    v_mfma_f32_16x16x32_bf16 v[118:121], a[156:159], a[108:111], v[118:121]
    ds_read_b64_tr_b16 a[134:135], v67 offset:37664
    ds_read_b128 a[116:119], v64 offset:6144
    v_cmp_lt_u32 vcc, 27, v1
    s_nop 1
    v_cndmask_b32 v25, v25, v2, vcc
    s_waitcnt lgkmcnt(13)
    v_mfma_f32_16x16x32_bf16 v[122:125], a[160:163], a[104:107], v[122:125]
    ds_read_b64_tr_b16 a[136:137], v68 offset:36864
    ds_read_b128 a[120:123], v65 offset:4096
    ds_read_b128 v[202:205], v72 offset:1472
    v_mfma_f32_16x16x32_bf16 v[126:129], a[160:163], a[108:111], v[126:129]
    ds_read_b64_tr_b16 a[138:139], v68 offset:37632
    ds_read_b128 a[124:127], v65 offset:6144
    s_xor_b32 s11, s36, 1
    s_waitcnt lgkmcnt(15)
    v_mfma_f32_16x16x32_bf16 v[130:133], a[164:167], a[104:107], v[130:133]
    ds_read_b128 v[206:209], v73 offset:1408
    s_mul_i32 s11, s11, 12288
    v_mfma_f32_16x16x32_bf16 v[134:137], a[164:167], a[108:111], v[134:137]
    ds_read_b64_tr_b16 a[140:141], v69 offset:36896
    s_add_u32 s11, s11, 98816
    s_waitcnt lgkmcnt(15)
    v_mfma_f32_16x16x32_bf16 v[138:141], a[168:171], a[104:107], v[138:141]
    ds_read_b64_tr_b16 a[142:143], v69 offset:37664
    ds_read_b128 v[210:213], v73 offset:1472
    v_mfma_f32_16x16x32_bf16 v[142:145], a[168:171], a[108:111], v[142:145]
    ds_read_b64_tr_b16 a[144:145], v70 offset:36864
    v_add_u32 v15, s11, v11
    s_waitcnt lgkmcnt(15)
    v_mfma_f32_16x16x32_bf16 v[146:149], a[172:175], a[104:107], v[146:149]
    ds_read_b64_tr_b16 a[146:147], v70 offset:37632
    ds_read_b128 v[214:217], v74 offset:1408
    v_mfma_f32_16x16x32_bf16 v[150:153], a[172:175], a[108:111], v[150:153]
    ds_read_b64_tr_b16 a[148:149], v71 offset:36896
    v_lshrrev_b32 v2, 1, v9
    v_mfma_f32_16x16x32_bf16 a[192:195], a[152:155], a[244:247], a[192:195]
    ds_read_b64_tr_b16 a[150:151], v71 offset:37664
    ds_read_b128 v[218:221], v74 offset:1472
    v_mfma_f32_16x16x32_bf16 a[196:199], a[156:159], a[244:247], a[196:199]
    v_lshlrev_b32 v2, 6, v2
    s_waitcnt lgkmcnt(10)
    v_mfma_f32_16x16x32_bf16 v[106:109], a[128:131], a[112:115], v[106:109]
    v_and_b32 v3, 1, v1
    ds_read_b64_tr_b16 a[152:153], v66 offset:43008
    v_mfma_f32_16x16x32_bf16 v[110:113], a[128:131], a[116:119], v[110:113]
    ds_read_b64_tr_b16 a[154:155], v66 offset:43776
    v_mfma_f32_16x16x32_bf16 a[192:195], a[128:131], a[244:247], a[192:195]
    v_lshl_add_u32 v2, v3, 3, v2
    v_mfma_f32_16x16x32_bf16 a[196:199], a[132:135], a[244:247], a[196:199]
    ds_read_b64_tr_b16 a[156:157], v67 offset:43040
    v_lshl_add_u32 v2, v10, 4, v2
    v_mfma_f32_16x16x32_bf16 v[114:117], a[132:135], a[112:115], v[114:117]
    ds_read_b64_tr_b16 a[158:159], v67 offset:43808
    s_add_u32 m0, s47, 4096
    s_nop 0
    buffer_load_dwordx4 v38, s[64:67], s41 offen offset:0 lds
    v_mfma_f32_16x16x32_bf16 v[118:121], a[132:135], a[116:119], v[118:121]
    ds_read_b64_tr_b16 a[160:161], v68 offset:43008
    s_waitcnt vmcnt(13)
    v_cmp_ne_u64 vcc, s[0:1], v[248:249]
    s_nop 0
    s_cmp_eq_u64 vcc, 0
    s_cbranch_scc0 L_sg
L_sg_ok:
    v_add_u32 v16, s47, v2
    v_mfma_f32_16x16x32_bf16 v[122:125], a[136:139], a[112:115], v[122:125]
    ds_read_b64_tr_b16 a[162:163], v68 offset:43776
    s_lshl_b32 s12, s8, 11
    v_mfma_f32_16x16x32_bf16 v[126:129], a[136:139], a[116:119], v[126:129]
    ds_read_b64_tr_b16 a[164:165], v69 offset:43040
    s_lshr_b32 s18, s18, 12
    s_waitcnt lgkmcnt(14)
    v_mfma_f32_16x16x32_bf16 v[130:133], a[140:143], a[112:115], v[130:133]
    ds_read_b64_tr_b16 a[166:167], v69 offset:43808
    buffer_load_dwordx4 v39, s[64:67], s41 offen offset:1024 lds
    v_mov_b32 v250, v246
    v_mfma_f32_16x16x32_bf16 v[134:137], a[140:143], a[116:119], v[134:137]
    ds_read_b64_tr_b16 a[168:169], v70 offset:43008
    s_mul_i32 s18, s18, 4352
    s_waitcnt lgkmcnt(7)
    v_mfma_f32_16x16x32_bf16 a[192:195], a[152:155], a[244:247], a[192:195]
    ds_read_b64_tr_b16 a[170:171], v70 offset:43776
    s_add_u32 s11, s18, s12
    s_waitcnt lgkmcnt(6)
    v_mfma_f32_16x16x32_bf16 a[196:199], a[156:159], a[244:247], a[196:199]
    ds_read_b64_tr_b16 a[172:173], v71 offset:43040
    ds_read_b64_tr_b16 a[174:175], v71 offset:43808
    v_mfma_f32_16x16x32_bf16 v[138:141], a[144:147], a[112:115], v[138:141]
    buffer_load_dwordx4 v40, s[64:67], s41 offen offset:2048 lds
    v_mov_b32 v251, v247
    v_mfma_f32_16x16x32_bf16 v[142:145], a[144:147], a[116:119], v[142:145]
    s_add_u32 s53, s11, 8388608
    buffer_load_dwordx4 v41, s[64:67], s41 offen offset:3072 lds
    v_mfma_f32_16x16x32_bf16 v[146:149], a[148:151], a[112:115], v[146:149]
    s_mov_b32 exec_lo, 0x00010001
    s_mov_b32 exec_hi, 0x00010001
    ds_write_b128 v72, a[192:195]
    ds_write_b128 v72, a[196:199] offset:64
    s_mov_b64 exec, -1
    v_mfma_f32_16x16x32_bf16 v[150:153], a[148:151], a[116:119], v[150:153]
    v_mov_b32 v252, v246
    s_waitcnt lgkmcnt(0)
    s_barrier
    ds_read_b128 v[222:225], v72 offset:0
    v_mfma_f32_16x16x32_bf16 v[106:109], a[152:155], a[120:123], v[106:109]
    ds_read_b128 v[226:229], v72 offset:64
    v_mov_b32 v253, v247
    v_mfma_f32_16x16x32_bf16 v[110:113], a[152:155], a[124:127], v[110:113]
    ds_read_b128 v[230:233], v73 offset:0
    v_mfma_f32_16x16x32_bf16 v[114:117], a[156:159], a[120:123], v[114:117]
    ds_read_b128 v[234:237], v73 offset:64
    v_mfma_f32_16x16x32_bf16 v[118:121], a[156:159], a[124:127], v[118:121]
    ds_read_b128 v[238:241], v74 offset:0
    v_mfma_f32_16x16x32_bf16 v[122:125], a[160:163], a[120:123], v[122:125]
    ds_read_b128 v[242:245], v74 offset:64
    v_permlane32_swap_b32 v250, v252
    v_mfma_f32_16x16x32_bf16 v[126:129], a[160:163], a[124:127], v[126:129]
    v_mfma_f32_16x16x32_bf16 v[130:133], a[164:167], a[120:123], v[130:133]
    ds_write_b128 v25, a[248:251]
    v_mfma_f32_16x16x32_bf16 v[134:137], a[164:167], a[124:127], v[134:137]
    v_permlane32_swap_b32 v251, v253
    v_mfma_f32_16x16x32_bf16 v[138:141], a[168:171], a[120:123], v[138:141]
    buffer_load_dwordx2 v[62:63], v19, s[76:79], 0 offen sc1
    v_mfma_f32_16x16x32_bf16 v[142:145], a[168:171], a[124:127], v[142:145]
    v_mfma_f32_16x16x32_bf16 v[146:149], a[172:175], a[120:123], v[146:149]
    v_mfma_f32_16x16x32_bf16 v[150:153], a[172:175], a[124:127], v[150:153]
    s_mov_b32 s14, 0xbdd2d3e8
    s_mov_b32 s15, 0xbdd2d3e8
    v_mov_b32 v6, 0xc0135761
    v_mov_b32 v7, 0xc0135761
    s_waitcnt lgkmcnt(1)
.p2align 3
    s_cmp_eq_u32 s20, 0x7f000000
    s_cbranch_scc1 L_gskip0
.p2align 3
    v_pk_fma_f32 v[64:65], v[222:223], v[250:251], v[198:199] op_sel:[0,1,0] op_sel_hi:[1,1,1] neg_lo:[0,1,0] neg_hi:[0,1,0]
    v_pk_fma_f32 v[66:67], v[224:225], v[250:251], v[200:201] op_sel:[0,1,0] op_sel_hi:[1,1,1] neg_lo:[0,1,0] neg_hi:[0,1,0]
    v_pk_fma_f32 v[68:69], v[226:227], v[250:251], v[202:203] op_sel:[0,1,0] op_sel_hi:[1,1,1] neg_lo:[0,1,0] neg_hi:[0,1,0]
    v_pk_fma_f32 v[70:71], v[228:229], v[250:251], v[204:205] op_sel:[0,1,0] op_sel_hi:[1,1,1] neg_lo:[0,1,0] neg_hi:[0,1,0]
    v_pk_fma_f32 v[106:107], v[106:107], v[250:251], v[64:65] op_sel_hi:[1,0,1]
    v_pk_fma_f32 v[108:109], v[108:109], v[250:251], v[66:67] op_sel_hi:[1,0,1]
    v_pk_fma_f32 v[114:115], v[114:115], v[250:251], v[68:69] op_sel_hi:[1,0,1]
    v_pk_fma_f32 v[116:117], v[116:117], v[250:251], v[70:71] op_sel_hi:[1,0,1]
    v_pk_mul_f32 v[64:65], v[106:107], v[106:107]
    v_pk_mul_f32 v[66:67], v[108:109], v[108:109]
    v_pk_mul_f32 v[68:69], v[114:115], v[114:115]
    v_pk_mul_f32 v[70:71], v[116:117], v[116:117]
    v_pk_fma_f32 v[64:65], v[64:65], s[14:15], v[6:7]
    ds_write_b128 v24, v[156:159] offset:12480
    v_pk_fma_f32 v[66:67], v[66:67], s[14:15], v[6:7]
    v_pk_fma_f32 v[68:69], v[68:69], s[14:15], v[6:7]
    v_pk_fma_f32 v[70:71], v[70:71], s[14:15], v[6:7]
    v_pk_mul_f32 v[64:65], v[64:65], v[106:107]
    v_pk_mul_f32 v[66:67], v[66:67], v[108:109]
    v_pk_mul_f32 v[68:69], v[68:69], v[114:115]
    v_pk_mul_f32 v[70:71], v[70:71], v[116:117]
    v_exp_f32 v64, v64
    v_exp_f32 v65, v65
    v_exp_f32 v66, v66
    v_exp_f32 v67, v67
    v_exp_f32 v68, v68
    v_exp_f32 v69, v69
    v_exp_f32 v70, v70
    v_exp_f32 v71, v71
    v_pk_add_f32 v[64:65], v[64:65], 1.0 op_sel_hi:[1,0]
    v_pk_add_f32 v[66:67], v[66:67], 1.0 op_sel_hi:[1,0]
    v_pk_add_f32 v[68:69], v[68:69], 1.0 op_sel_hi:[1,0]
    v_pk_add_f32 v[70:71], v[70:71], 1.0 op_sel_hi:[1,0]
    ds_write_b128 v24, v[170:173] offset:8320
    v_rcp_f32 v64, v64
    v_rcp_f32 v65, v65
    v_rcp_f32 v66, v66
    v_rcp_f32 v67, v67
    v_rcp_f32 v68, v68
    v_rcp_f32 v69, v69
    v_rcp_f32 v70, v70
    v_rcp_f32 v71, v71
    v_pk_mul_f32 v[64:65], v[64:65], v[106:107]
    v_pk_mul_f32 v[66:67], v[66:67], v[108:109]
    v_pk_mul_f32 v[68:69], v[68:69], v[114:115]
    v_pk_mul_f32 v[70:71], v[70:71], v[116:117]
    v_cvt_pk_bf16_f32 v80, v64, v65
    v_cvt_pk_bf16_f32 v81, v66, v67
    v_cvt_pk_bf16_f32 v82, v68, v69
    v_cvt_pk_bf16_f32 v83, v70, v71
    buffer_store_dwordx4 v[80:83], v11, s[76:79], s20 offen sc1
    s_add_u32 s20, s20, 44032
    v_pk_fma_f32 v[72:73], v[222:223], v[252:253], v[198:199] op_sel:[0,1,0] op_sel_hi:[1,1,1] neg_lo:[0,1,0] neg_hi:[0,1,0]
    v_pk_fma_f32 v[74:75], v[224:225], v[252:253], v[200:201] op_sel:[0,1,0] op_sel_hi:[1,1,1] neg_lo:[0,1,0] neg_hi:[0,1,0]
    ds_write_b128 v24, v[162:165] offset:13504
    v_pk_fma_f32 v[76:77], v[226:227], v[252:253], v[202:203] op_sel:[0,1,0] op_sel_hi:[1,1,1] neg_lo:[0,1,0] neg_hi:[0,1,0]
    v_pk_fma_f32 v[78:79], v[228:229], v[252:253], v[204:205] op_sel:[0,1,0] op_sel_hi:[1,1,1] neg_lo:[0,1,0] neg_hi:[0,1,0]
    v_pk_fma_f32 v[110:111], v[110:111], v[252:253], v[72:73] op_sel_hi:[1,0,1]
    v_pk_fma_f32 v[112:113], v[112:113], v[252:253], v[74:75] op_sel_hi:[1,0,1]
    v_pk_fma_f32 v[118:119], v[118:119], v[252:253], v[76:77] op_sel_hi:[1,0,1]
    v_pk_fma_f32 v[120:121], v[120:121], v[252:253], v[78:79] op_sel_hi:[1,0,1]
    v_pk_mul_f32 v[72:73], v[110:111], v[110:111]
    v_pk_mul_f32 v[74:75], v[112:113], v[112:113]
    v_pk_mul_f32 v[76:77], v[118:119], v[118:119]
    v_pk_mul_f32 v[78:79], v[120:121], v[120:121]
    v_pk_fma_f32 v[72:73], v[72:73], s[14:15], v[6:7]
    v_pk_fma_f32 v[74:75], v[74:75], s[14:15], v[6:7]
    v_pk_fma_f32 v[76:77], v[76:77], s[14:15], v[6:7]
    v_pk_fma_f32 v[78:79], v[78:79], s[14:15], v[6:7]
    v_pk_mul_f32 v[72:73], v[72:73], v[110:111]
    v_pk_mul_f32 v[74:75], v[74:75], v[112:113]
    v_pk_mul_f32 v[76:77], v[76:77], v[118:119]
    v_pk_mul_f32 v[78:79], v[78:79], v[120:121]
    v_exp_f32 v72, v72
    v_exp_f32 v73, v73
    ds_write_b128 v24, v[182:185] offset:9344
    v_exp_f32 v74, v74
    v_exp_f32 v75, v75
    v_exp_f32 v76, v76
    v_exp_f32 v77, v77
    v_exp_f32 v78, v78
    v_exp_f32 v79, v79
    v_pk_add_f32 v[72:73], v[72:73], 1.0 op_sel_hi:[1,0]
    v_pk_add_f32 v[74:75], v[74:75], 1.0 op_sel_hi:[1,0]
    v_pk_add_f32 v[76:77], v[76:77], 1.0 op_sel_hi:[1,0]
    v_pk_add_f32 v[78:79], v[78:79], 1.0 op_sel_hi:[1,0]
    v_rcp_f32 v72, v72
    v_rcp_f32 v73, v73
    v_rcp_f32 v74, v74
    v_rcp_f32 v75, v75
    v_rcp_f32 v76, v76
    v_rcp_f32 v77, v77
    v_rcp_f32 v78, v78
    v_rcp_f32 v79, v79
    v_pk_mul_f32 v[72:73], v[72:73], v[110:111]
    v_pk_mul_f32 v[74:75], v[74:75], v[112:113]
    v_pk_mul_f32 v[76:77], v[76:77], v[118:119]
    v_pk_mul_f32 v[78:79], v[78:79], v[120:121]
    v_cvt_pk_bf16_f32 v84, v72, v73
    v_cvt_pk_bf16_f32 v85, v74, v75
    v_cvt_pk_bf16_f32 v86, v76, v77
    v_cvt_pk_bf16_f32 v87, v78, v79
    buffer_store_dwordx4 v[84:87], v11, s[76:79], s20 offen sc1
L_gdone0:
    s_waitcnt vmcnt(2)
    v_cmp_ne_u64 vcc, s[0:1], v[62:63]
    s_nop 0
    s_cmp_eq_u64 vcc, 0
    s_cbranch_scc0 L_pf1
L_pf1_ok:
    s_add_u32 s60, s76, s18
    s_addc_u32 s61, s77, 0
    s_mov_b32 m0, s55
    s_cmp_eq_u32 s21, 0x7f000000
    s_cbranch_scc1 L_gskip1
.p2align 3
    v_pk_fma_f32 v[64:65], v[230:231], v[250:251], v[206:207] op_sel:[0,1,0] op_sel_hi:[1,1,1] neg_lo:[0,1,0] neg_hi:[0,1,0]
    v_pk_fma_f32 v[66:67], v[232:233], v[250:251], v[208:209] op_sel:[0,1,0] op_sel_hi:[1,1,1] neg_lo:[0,1,0] neg_hi:[0,1,0]
    v_pk_fma_f32 v[68:69], v[234:235], v[250:251], v[210:211] op_sel:[0,1,0] op_sel_hi:[1,1,1] neg_lo:[0,1,0] neg_hi:[0,1,0]
    buffer_load_dwordx4 v11, s[60:63], s56 offen offset:0 sc1 lds
    v_pk_fma_f32 v[70:71], v[236:237], v[250:251], v[212:213] op_sel:[0,1,0] op_sel_hi:[1,1,1] neg_lo:[0,1,0] neg_hi:[0,1,0]
    v_pk_fma_f32 v[122:123], v[122:123], v[250:251], v[64:65] op_sel_hi:[1,0,1]
    v_pk_fma_f32 v[124:125], v[124:125], v[250:251], v[66:67] op_sel_hi:[1,0,1]
    v_pk_fma_f32 v[130:131], v[130:131], v[250:251], v[68:69] op_sel_hi:[1,0,1]
    v_pk_fma_f32 v[132:133], v[132:133], v[250:251], v[70:71] op_sel_hi:[1,0,1]
    v_pk_mul_f32 v[64:65], v[122:123], v[122:123]
    v_pk_mul_f32 v[66:67], v[124:125], v[124:125]
    v_pk_mul_f32 v[68:69], v[130:131], v[130:131]
    v_pk_mul_f32 v[70:71], v[132:133], v[132:133]
    v_pk_fma_f32 v[64:65], v[64:65], s[14:15], v[6:7]
    ds_write_b128 v24, v[166:169] offset:0
    v_pk_fma_f32 v[66:67], v[66:67], s[14:15], v[6:7]
    v_pk_fma_f32 v[68:69], v[68:69], s[14:15], v[6:7]
    v_pk_fma_f32 v[70:71], v[70:71], s[14:15], v[6:7]
    v_pk_mul_f32 v[64:65], v[64:65], v[122:123]
    buffer_load_dwordx4 v11, s[60:63], s56 offen offset:1024 sc1 lds
    v_pk_mul_f32 v[66:67], v[66:67], v[124:125]
    v_pk_mul_f32 v[68:69], v[68:69], v[130:131]
    v_pk_mul_f32 v[70:71], v[70:71], v[132:133]
    v_exp_f32 v64, v64
    v_exp_f32 v65, v65
    v_exp_f32 v66, v66
    v_exp_f32 v67, v67
    v_exp_f32 v68, v68
    v_exp_f32 v69, v69
    v_exp_f32 v70, v70
    v_exp_f32 v71, v71
    v_pk_add_f32 v[64:65], v[64:65], 1.0 op_sel_hi:[1,0]
    v_pk_add_f32 v[66:67], v[66:67], 1.0 op_sel_hi:[1,0]
    v_pk_add_f32 v[68:69], v[68:69], 1.0 op_sel_hi:[1,0]
    v_pk_add_f32 v[70:71], v[70:71], 1.0 op_sel_hi:[1,0]
    buffer_load_dwordx4 v11, s[60:63], s56 offen offset:2048 sc1 lds
    ds_write_b128 v24, v[174:177] offset:4160
    v_rcp_f32 v64, v64
    v_rcp_f32 v65, v65
    v_rcp_f32 v66, v66
    v_rcp_f32 v67, v67
    v_rcp_f32 v68, v68
    v_rcp_f32 v69, v69
    v_rcp_f32 v70, v70
    v_rcp_f32 v71, v71
    v_pk_mul_f32 v[64:65], v[64:65], v[122:123]
    v_pk_mul_f32 v[66:67], v[66:67], v[124:125]
    v_pk_mul_f32 v[68:69], v[68:69], v[130:131]
    v_pk_mul_f32 v[70:71], v[70:71], v[132:133]
    v_cvt_pk_bf16_f32 v80, v64, v65
    v_cvt_pk_bf16_f32 v81, v66, v67
    v_cvt_pk_bf16_f32 v82, v68, v69
    buffer_load_dwordx4 v11, s[60:63], s56 offen offset:3072 sc1 lds
    v_cvt_pk_bf16_f32 v83, v70, v71
    buffer_store_dwordx4 v[80:83], v11, s[76:79], s21 offen sc1
    s_add_u32 s21, s21, 44032
    v_pk_fma_f32 v[72:73], v[230:231], v[252:253], v[206:207] op_sel:[0,1,0] op_sel_hi:[1,1,1] neg_lo:[0,1,0] neg_hi:[0,1,0]
    v_pk_fma_f32 v[74:75], v[232:233], v[252:253], v[208:209] op_sel:[0,1,0] op_sel_hi:[1,1,1] neg_lo:[0,1,0] neg_hi:[0,1,0]
    ds_write_b128 v24, v[178:181] offset:1024
    v_pk_fma_f32 v[76:77], v[234:235], v[252:253], v[210:211] op_sel:[0,1,0] op_sel_hi:[1,1,1] neg_lo:[0,1,0] neg_hi:[0,1,0]
    v_pk_fma_f32 v[78:79], v[236:237], v[252:253], v[212:213] op_sel:[0,1,0] op_sel_hi:[1,1,1] neg_lo:[0,1,0] neg_hi:[0,1,0]
    v_pk_fma_f32 v[126:127], v[126:127], v[252:253], v[72:73] op_sel_hi:[1,0,1]
    v_pk_fma_f32 v[128:129], v[128:129], v[252:253], v[74:75] op_sel_hi:[1,0,1]
    v_pk_fma_f32 v[134:135], v[134:135], v[252:253], v[76:77] op_sel_hi:[1,0,1]
    v_pk_fma_f32 v[136:137], v[136:137], v[252:253], v[78:79] op_sel_hi:[1,0,1]
    v_pk_mul_f32 v[72:73], v[126:127], v[126:127]
    v_pk_mul_f32 v[74:75], v[128:129], v[128:129]
    v_pk_mul_f32 v[76:77], v[134:135], v[134:135]
    v_pk_mul_f32 v[78:79], v[136:137], v[136:137]
    v_pk_fma_f32 v[72:73], v[72:73], s[14:15], v[6:7]
    v_pk_fma_f32 v[74:75], v[74:75], s[14:15], v[6:7]
    v_pk_fma_f32 v[76:77], v[76:77], s[14:15], v[6:7]
    v_pk_fma_f32 v[78:79], v[78:79], s[14:15], v[6:7]
    v_pk_mul_f32 v[72:73], v[72:73], v[126:127]
    v_pk_mul_f32 v[74:75], v[74:75], v[128:129]
    v_pk_mul_f32 v[76:77], v[76:77], v[134:135]
    v_pk_mul_f32 v[78:79], v[78:79], v[136:137]
    v_exp_f32 v72, v72
    v_exp_f32 v73, v73
    ds_write_b128 v24, v[186:189] offset:5184
    v_exp_f32 v74, v74
    v_exp_f32 v75, v75
    v_exp_f32 v76, v76
    v_exp_f32 v77, v77
    v_exp_f32 v78, v78
    v_exp_f32 v79, v79
    v_pk_add_f32 v[72:73], v[72:73], 1.0 op_sel_hi:[1,0]
    v_pk_add_f32 v[74:75], v[74:75], 1.0 op_sel_hi:[1,0]
    v_pk_add_f32 v[76:77], v[76:77], 1.0 op_sel_hi:[1,0]
    v_pk_add_f32 v[78:79], v[78:79], 1.0 op_sel_hi:[1,0]
    v_rcp_f32 v72, v72
    v_rcp_f32 v73, v73
    v_rcp_f32 v74, v74
    v_rcp_f32 v75, v75
    v_rcp_f32 v76, v76
    v_rcp_f32 v77, v77
    v_rcp_f32 v78, v78
    v_rcp_f32 v79, v79
    v_pk_mul_f32 v[72:73], v[72:73], v[126:127]
    v_pk_mul_f32 v[74:75], v[74:75], v[128:129]
    v_pk_mul_f32 v[76:77], v[76:77], v[134:135]
    v_pk_mul_f32 v[78:79], v[78:79], v[136:137]
    v_cvt_pk_bf16_f32 v84, v72, v73
    v_cvt_pk_bf16_f32 v85, v74, v75
    v_cvt_pk_bf16_f32 v86, v76, v77
    v_cvt_pk_bf16_f32 v87, v78, v79
    buffer_store_dwordx4 v[84:87], v11, s[76:79], s21 offen sc1
L_gdone1:
    s_cmp_eq_u32 s22, 0x7f000000
    s_cbranch_scc1 L_gskip2
.p2align 3
    v_pk_fma_f32 v[64:65], v[238:239], v[250:251], v[214:215] op_sel:[0,1,0] op_sel_hi:[1,1,1] neg_lo:[0,1,0] neg_hi:[0,1,0]
    v_pk_fma_f32 v[66:67], v[240:241], v[250:251], v[216:217] op_sel:[0,1,0] op_sel_hi:[1,1,1] neg_lo:[0,1,0] neg_hi:[0,1,0]
    v_pk_fma_f32 v[68:69], v[242:243], v[250:251], v[218:219] op_sel:[0,1,0] op_sel_hi:[1,1,1] neg_lo:[0,1,0] neg_hi:[0,1,0]
    v_pk_fma_f32 v[70:71], v[244:245], v[250:251], v[220:221] op_sel:[0,1,0] op_sel_hi:[1,1,1] neg_lo:[0,1,0] neg_hi:[0,1,0]
    v_pk_fma_f32 v[138:139], v[138:139], v[250:251], v[64:65] op_sel_hi:[1,0,1]
    v_pk_fma_f32 v[140:141], v[140:141], v[250:251], v[66:67] op_sel_hi:[1,0,1]
    v_pk_fma_f32 v[146:147], v[146:147], v[250:251], v[68:69] op_sel_hi:[1,0,1]
    v_pk_fma_f32 v[148:149], v[148:149], v[250:251], v[70:71] op_sel_hi:[1,0,1]
    v_pk_mul_f32 v[64:65], v[138:139], v[138:139]
    v_pk_mul_f32 v[66:67], v[140:141], v[140:141]
    v_pk_mul_f32 v[68:69], v[146:147], v[146:147]
    v_pk_mul_f32 v[70:71], v[148:149], v[148:149]
    v_pk_fma_f32 v[64:65], v[64:65], s[14:15], v[6:7]
    v_pk_fma_f32 v[66:67], v[66:67], s[14:15], v[6:7]
    v_pk_fma_f32 v[68:69], v[68:69], s[14:15], v[6:7]
    v_pk_fma_f32 v[70:71], v[70:71], s[14:15], v[6:7]
    v_pk_mul_f32 v[64:65], v[64:65], v[138:139]
    v_pk_mul_f32 v[66:67], v[66:67], v[140:141]
    v_pk_mul_f32 v[68:69], v[68:69], v[146:147]
    v_pk_mul_f32 v[70:71], v[70:71], v[148:149]
    v_exp_f32 v64, v64
    v_exp_f32 v65, v65
    v_exp_f32 v66, v66
    v_exp_f32 v67, v67
    v_exp_f32 v68, v68
    v_exp_f32 v69, v69
    v_exp_f32 v70, v70
    v_exp_f32 v71, v71
    v_pk_add_f32 v[64:65], v[64:65], 1.0 op_sel_hi:[1,0]
    v_pk_add_f32 v[66:67], v[66:67], 1.0 op_sel_hi:[1,0]
    v_pk_add_f32 v[68:69], v[68:69], 1.0 op_sel_hi:[1,0]
    v_pk_add_f32 v[70:71], v[70:71], 1.0 op_sel_hi:[1,0]
    v_rcp_f32 v64, v64
    v_rcp_f32 v65, v65
    v_rcp_f32 v66, v66
    v_rcp_f32 v67, v67
    v_rcp_f32 v68, v68
    v_rcp_f32 v69, v69
    v_rcp_f32 v70, v70
    v_rcp_f32 v71, v71
    v_pk_mul_f32 v[64:65], v[64:65], v[138:139]
    v_pk_mul_f32 v[66:67], v[66:67], v[140:141]
    v_pk_mul_f32 v[68:69], v[68:69], v[146:147]
    v_pk_mul_f32 v[70:71], v[70:71], v[148:149]
    v_cvt_pk_bf16_f32 v80, v64, v65
    v_cvt_pk_bf16_f32 v81, v66, v67
    v_cvt_pk_bf16_f32 v82, v68, v69
    v_cvt_pk_bf16_f32 v83, v70, v71
    buffer_store_dwordx4 v[80:83], v11, s[76:79], s22 offen sc1
    s_add_u32 s22, s22, 44032
    v_pk_fma_f32 v[72:73], v[238:239], v[252:253], v[214:215] op_sel:[0,1,0] op_sel_hi:[1,1,1] neg_lo:[0,1,0] neg_hi:[0,1,0]
    v_pk_fma_f32 v[74:75], v[240:241], v[252:253], v[216:217] op_sel:[0,1,0] op_sel_hi:[1,1,1] neg_lo:[0,1,0] neg_hi:[0,1,0]
    v_pk_fma_f32 v[76:77], v[242:243], v[252:253], v[218:219] op_sel:[0,1,0] op_sel_hi:[1,1,1] neg_lo:[0,1,0] neg_hi:[0,1,0]
    v_pk_fma_f32 v[78:79], v[244:245], v[252:253], v[220:221] op_sel:[0,1,0] op_sel_hi:[1,1,1] neg_lo:[0,1,0] neg_hi:[0,1,0]
    v_pk_fma_f32 v[142:143], v[142:143], v[252:253], v[72:73] op_sel_hi:[1,0,1]
    v_pk_fma_f32 v[144:145], v[144:145], v[252:253], v[74:75] op_sel_hi:[1,0,1]
    v_pk_fma_f32 v[150:151], v[150:151], v[252:253], v[76:77] op_sel_hi:[1,0,1]
    v_pk_fma_f32 v[152:153], v[152:153], v[252:253], v[78:79] op_sel_hi:[1,0,1]
    v_pk_mul_f32 v[72:73], v[142:143], v[142:143]
    v_pk_mul_f32 v[74:75], v[144:145], v[144:145]
    v_pk_mul_f32 v[76:77], v[150:151], v[150:151]
    v_pk_mul_f32 v[78:79], v[152:153], v[152:153]
    v_pk_fma_f32 v[72:73], v[72:73], s[14:15], v[6:7]
    v_pk_fma_f32 v[74:75], v[74:75], s[14:15], v[6:7]
    v_pk_fma_f32 v[76:77], v[76:77], s[14:15], v[6:7]
    v_pk_fma_f32 v[78:79], v[78:79], s[14:15], v[6:7]
    v_pk_mul_f32 v[72:73], v[72:73], v[142:143]
    v_pk_mul_f32 v[74:75], v[74:75], v[144:145]
    v_pk_mul_f32 v[76:77], v[76:77], v[150:151]
    v_pk_mul_f32 v[78:79], v[78:79], v[152:153]
    v_exp_f32 v72, v72
    v_exp_f32 v73, v73
    v_exp_f32 v74, v74
    v_exp_f32 v75, v75
    v_exp_f32 v76, v76
    v_exp_f32 v77, v77
    v_exp_f32 v78, v78
    v_exp_f32 v79, v79
    v_pk_add_f32 v[72:73], v[72:73], 1.0 op_sel_hi:[1,0]
    v_pk_add_f32 v[74:75], v[74:75], 1.0 op_sel_hi:[1,0]
    s_waitcnt vmcnt(3) lgkmcnt(0)
    s_barrier
    v_pk_add_f32 v[76:77], v[76:77], 1.0 op_sel_hi:[1,0]
    ds_read_b128 a[204:207], v13 offset:3584
    v_pk_add_f32 v[78:79], v[78:79], 1.0 op_sel_hi:[1,0]
    v_rcp_f32 v72, v72
    ds_read_b128 a[208:211], v14 offset:3584
    v_rcp_f32 v73, v73
    v_rcp_f32 v74, v74
    v_rcp_f32 v75, v75
    ds_read_b128 a[200:203], v13 offset:3072
    v_rcp_f32 v76, v76
    v_rcp_f32 v77, v77
    v_rcp_f32 v78, v78
    ds_read_b128 a[212:215], v14 offset:3072
    v_rcp_f32 v79, v79
    v_pk_mul_f32 v[72:73], v[72:73], v[142:143]
    v_pk_mul_f32 v[74:75], v[74:75], v[144:145]
    ds_read_b128 a[196:199], v13 offset:2560
    v_pk_mul_f32 v[76:77], v[76:77], v[150:151]
    v_pk_mul_f32 v[78:79], v[78:79], v[152:153]
    v_cvt_pk_bf16_f32 v84, v72, v73
    ds_read_b128 a[216:219], v14 offset:2560
    v_cvt_pk_bf16_f32 v85, v74, v75
    v_cvt_pk_bf16_f32 v86, v76, v77
    v_cvt_pk_bf16_f32 v87, v78, v79
    buffer_store_dwordx4 v[84:87], v11, s[76:79], s22 offen sc1
L_gdone2:
    s_waitcnt lgkmcnt(4)
    v_mfma_f32_16x16x32_bf16 v[124:127], a[204:207], a[208:211], 0
    ds_read_b128 a[192:195], v13 offset:2048
    s_waitcnt lgkmcnt(4)
    v_mfma_f32_16x16x32_bf16 v[120:123], a[200:203], a[208:211], 0
    ds_read_b128 a[220:223], v14 offset:2048
    s_waitcnt lgkmcnt(4)
    v_mfma_f32_16x16x32_bf16 v[124:127], a[200:203], a[212:215], v[124:127]
    ds_read_b128 a[188:191], v13 offset:1536
    s_waitcnt lgkmcnt(4)
    v_mfma_f32_16x16x32_bf16 v[116:119], a[196:199], a[208:211], 0
    ds_read_b128 a[224:227], v14 offset:1536
    v_mfma_f32_16x16x32_bf16 v[120:123], a[196:199], a[212:215], v[120:123]
    ds_read_b128 a[184:187], v13 offset:1024
    s_add_u32 m0, s32, 49664
    s_nop 0
    buffer_load_dwordx4 v38, s[64:67], s83 offen offset:0 lds
    s_waitcnt lgkmcnt(5)
    v_mfma_f32_16x16x32_bf16 v[124:127], a[196:199], a[216:219], v[124:127]
    ds_read_b128 a[228:231], v14 offset:1024
    v_lshrrev_b32 v17, 1, v1
    s_waitcnt lgkmcnt(5)
    v_mfma_f32_16x16x32_bf16 v[112:115], a[192:195], a[208:211], 0
    ds_read_b128 a[180:183], v13 offset:512
    v_mul_u32_u24 v17, 4352, v17
    v_mfma_f32_16x16x32_bf16 v[116:119], a[192:195], a[212:215], v[116:119]
    ds_read_b128 a[232:235], v14 offset:512
    v_and_b32 v3, 1, v1
    v_mfma_f32_16x16x32_bf16 v[120:123], a[192:195], a[216:219], v[120:123]
    ds_read_b128 a[176:179], v13 offset:0
    buffer_load_dwordx4 v39, s[64:67], s83 offen offset:1024 lds
    s_waitcnt lgkmcnt(7)
    v_mfma_f32_16x16x32_bf16 v[124:127], a[192:195], a[220:223], v[124:127]
    ds_read_b128 a[236:239], v14 offset:0
    ds_read_b128 a[204:207], v13 offset:3648
    ds_read_b128 a[200:203], v13 offset:3136
    ds_read_b128 a[196:199], v13 offset:2624
    v_lshl_add_u32 v17, v3, 4, v17
    s_waitcnt lgkmcnt(10)
    v_mfma_f32_16x16x32_bf16 v[108:111], a[188:191], a[208:211], 0
    ds_read_b128 a[192:195], v13 offset:2112
    ds_read_b64_tr_b16 a[0:1], v46 offset:33280
    v_mfma_f32_16x16x32_bf16 v[112:115], a[188:191], a[212:215], v[112:115]
    ds_read_b64_tr_b16 a[2:3], v46 offset:35328
    s_mul_i32 s11, s40, 278528
    s_lshl_b32 s12, s44, 5
    v_mfma_f32_16x16x32_bf16 v[116:119], a[188:191], a[216:219], v[116:119]
    ds_read_b64_tr_b16 a[4:5], v47 offset:33280
    buffer_load_dwordx4 v40, s[64:67], s83 offen offset:2048 lds
    v_mfma_f32_16x16x32_bf16 v[120:123], a[188:191], a[220:223], v[120:123]
    ds_read_b64_tr_b16 a[6:7], v47 offset:35328
    s_add_u32 s11, s11, s12
    s_waitcnt lgkmcnt(14)
    v_mfma_f32_16x16x32_bf16 v[124:127], a[188:191], a[224:227], v[124:127]
    ds_read_b64_tr_b16 a[8:9], v48 offset:33280
    s_add_u32 s54, s11, 8388608
    s_waitcnt lgkmcnt(14)
    v_mfma_f32_16x16x32_bf16 v[104:107], a[184:187], a[208:211], 0
    ds_read_b128 a[188:191], v13 offset:1600
    buffer_load_dwordx4 v41, s[64:67], s83 offen offset:3072 lds
    v_mfma_f32_16x16x32_bf16 v[108:111], a[184:187], a[212:215], v[108:111]
    ds_read_b64_tr_b16 a[10:11], v48 offset:35328
    s_add_u32 s11, s36, 1
    v_mfma_f32_16x16x32_bf16 v[112:115], a[184:187], a[216:219], v[112:115]
    ds_read_b64_tr_b16 a[12:13], v49 offset:33280
    v_mfma_f32_16x16x32_bf16 v[116:119], a[184:187], a[220:223], v[116:119]
    ds_read_b64_tr_b16 a[14:15], v49 offset:35328
    s_and_b32 s11, s11, 3
    v_mfma_f32_16x16x32_bf16 v[120:123], a[184:187], a[224:227], v[120:123]
    ds_read_b64_tr_b16 a[16:17], v42 offset:8192
    s_mul_i32 s12, s11, 12288
    s_waitcnt lgkmcnt(15)
    v_mfma_f32_16x16x32_bf16 v[124:127], a[184:187], a[228:231], v[124:127]
    ds_read_b128 a[184:187], v13 offset:1088
    v_mfma_f32_16x16x32_bf16 v[100:103], a[180:183], a[208:211], 0
    ds_read_b64_tr_b16 a[18:19], v42 offset:10240
    s_add_u32 s12, s12, 49664
    v_mfma_f32_16x16x32_bf16 v[104:107], a[180:183], a[212:215], v[104:107]
    ds_read_b64_tr_b16 a[20:21], v43 offset:8192
    v_lshl_add_u32 v54, v1, 3, s12
    v_mfma_f32_16x16x32_bf16 v[108:111], a[180:183], a[216:219], v[108:111]
    ds_read_b64_tr_b16 a[22:23], v43 offset:10240
    v_mfma_f32_16x16x32_bf16 v[112:115], a[180:183], a[220:223], v[112:115]
    ds_read_b64_tr_b16 a[24:25], v44 offset:8192
    s_lshl_b32 s12, s39, 2
    v_mfma_f32_16x16x32_bf16 v[116:119], a[180:183], a[224:227], v[116:119]
    s_add_u32 m0, s32, 33280
    s_waitcnt lgkmcnt(6)
    buffer_load_dwordx4 v38, s[64:67], s84 offen offset:0 lds
    s_add_u32 s11, s11, s12
    v_mfma_f32_16x16x32_bf16 v[120:123], a[180:183], a[228:231], v[120:123]
    ds_read_b64_tr_b16 a[26:27], v44 offset:10240
    v_mfma_f32_16x16x32_bf16 v[124:127], a[180:183], a[232:235], v[124:127]
    ds_read_b128 a[180:183], v13 offset:576
    s_mul_i32 s11, s11, 44032
    v_mfma_f32_16x16x32_bf16 v[96:99], a[176:179], a[208:211], 0
    ds_read_b64_tr_b16 a[28:29], v45 offset:8192
    buffer_load_dwordx4 v39, s[64:67], s84 offen offset:1024 lds
    v_mfma_f32_16x16x32_bf16 v[96:99], a[240:243], a[208:211], v[96:99]
    ds_read_b128 a[208:211], v14 offset:3648
    ds_read_b64_tr_b16 a[30:31], v45 offset:10240
    v_mfma_f32_16x16x32_bf16 v[100:103], a[176:179], a[212:215], v[100:103]
    s_add_u32 s11, s11, 2359296
    ds_read_b64_tr_b16 a[32:33], v42 offset:0
    v_mfma_f32_16x16x32_bf16 v[100:103], a[240:243], a[212:215], v[100:103]
    ds_read_b128 a[212:215], v14 offset:3136
    v_add_u32 v50, s11, v11
    v_mfma_f32_16x16x32_bf16 v[104:107], a[176:179], a[216:219], v[104:107]
    ds_read_b64_tr_b16 a[34:35], v42 offset:2048
    buffer_load_dwordx4 v40, s[64:67], s84 offen offset:2048 lds
    s_waitcnt vmcnt(7)
    s_mov_b64 exec, 15
    buffer_store_dwordx4 v[30:33], v11, s[76:79], s51 offen sc1
    s_mov_b64 exec, -1
    v_mfma_f32_16x16x32_bf16 v[104:107], a[240:243], a[216:219], v[104:107]
    ds_read_b128 a[216:219], v14 offset:2624
    s_lshr_b32 s9, s33, 5
    s_min_u32 s9, s9, 43008
    s_add_u32 s11, s36, 2
    v_mfma_f32_16x16x32_bf16 v[108:111], a[176:179], a[220:223], v[108:111]
    ds_read_b64_tr_b16 a[36:37], v43 offset:0
    s_and_b32 s11, s11, 3
    s_lshr_b32 s14, s34, 5
    s_min_u32 s14, s14, 43008
    v_mfma_f32_16x16x32_bf16 v[108:111], a[240:243], a[220:223], v[108:111]
    ds_read_b128 a[220:223], v14 offset:2112
    ds_read_b64_tr_b16 a[38:39], v43 offset:2048
    v_mfma_f32_16x16x32_bf16 v[112:115], a[176:179], a[224:227], v[112:115]
    ds_read_b64_tr_b16 a[40:41], v44 offset:0
    buffer_load_dwordx4 v41, s[64:67], s84 offen offset:3072 lds
    s_mul_i32 s12, s11, 12288
    v_mfma_f32_16x16x32_bf16 v[112:115], a[240:243], a[224:227], v[112:115]
    ds_read_b128 a[224:227], v14 offset:1600
    ds_read_b64_tr_b16 a[42:43], v44 offset:2048
    s_add_u32 s12, s12, 53760
    v_mfma_f32_16x16x32_bf16 v[116:119], a[176:179], a[228:231], v[116:119]
    ds_read_b64_tr_b16 a[44:45], v45 offset:0
    v_lshl_add_u32 v55, v1, 3, s12
    v_mfma_f32_16x16x32_bf16 v[116:119], a[240:243], a[228:231], v[116:119]
    ds_read_b128 a[228:231], v14 offset:1088
    s_lshr_b32 s15, s35, 5
    s_min_u32 s15, s15, 43008
    s_lshl_b32 s12, s39, 2
    v_mfma_f32_16x16x32_bf16 v[120:123], a[176:179], a[232:235], v[120:123]
    ds_read_b64_tr_b16 a[46:47], v45 offset:2048
    s_add_u32 m0, s47, 8192
    s_waitcnt lgkmcnt(13)
    buffer_load_dwordx4 v38, s[64:67], s85 offen offset:0 lds
    v_mfma_f32_16x16x32_bf16 v[120:123], a[240:243], a[232:235], v[120:123]
    ds_read_b128 a[232:235], v14 offset:576
    s_add_u32 s11, s11, s12
    v_mfma_f32_16x16x32_bf16 v[124:127], a[176:179], a[236:239], v[124:127]
    ds_read_b64_tr_b16 a[48:49], v42 offset:4096
    s_lshr_b32 s20, s41, 5
    s_min_u32 s20, s20, 43008
    v_mfma_f32_16x16x32_bf16 v[124:127], a[240:243], a[236:239], v[124:127]
    ds_read_b128 a[236:239], v14 offset:64
    ds_read_b128 a[176:179], v13 offset:64
    ds_read_b64_tr_b16 a[50:51], v42 offset:6144
    v_mfma_f32_16x16x32_bf16 v[124:127], a[204:207], a[208:211], v[124:127]
    ds_read_b64_tr_b16 a[52:53], v43 offset:4096
    buffer_load_dwordx4 v39, s[64:67], s85 offen offset:1024 lds
    s_mul_i32 s11, s11, 44032
    v_mfma_f32_16x16x32_bf16 v[120:123], a[200:203], a[208:211], v[120:123]
    ds_read_b128 a[204:207], v13 offset:3712
    s_add_u32 s11, s11, 2359296
    s_waitcnt lgkmcnt(15)
    v_mfma_f32_16x16x32_bf16 v[124:127], a[200:203], a[212:215], v[124:127]
    ds_read_b64_tr_b16 a[54:55], v43 offset:6144
    s_lshr_b32 s21, s83, 5
    s_min_u32 s21, s21, 43008
    v_mfma_f32_16x16x32_bf16 v[116:119], a[196:199], a[208:211], v[116:119]
    ds_read_b128 a[200:203], v13 offset:3200
    ds_read_b64_tr_b16 a[56:57], v44 offset:4096
    v_add_u32 v51, s11, v11
    v_mfma_f32_16x16x32_bf16 v[120:123], a[196:199], a[212:215], v[120:123]
    ds_read_b64_tr_b16 a[58:59], v44 offset:6144
    buffer_load_dwordx4 v40, s[64:67], s85 offen offset:2048 lds
    s_add_u32 s11, s36, 3
    v_mfma_f32_16x16x32_bf16 v[124:127], a[196:199], a[216:219], v[124:127]
    ds_read_b64_tr_b16 a[60:61], v45 offset:4096
    s_and_b32 s11, s11, 3
    v_mfma_f32_16x16x32_bf16 v[112:115], a[192:195], a[208:211], v[112:115]
    ds_read_b128 a[196:199], v13 offset:2688
    ds_read_b64_tr_b16 a[62:63], v45 offset:6144
    v_mfma_f32_16x16x32_bf16 v[116:119], a[192:195], a[212:215], v[116:119]
    buffer_load_dwordx4 v41, s[64:67], s85 offen offset:3072 lds
    s_lshr_b32 s22, s84, 5
    s_min_u32 s22, s22, 43008
    s_mul_i32 s12, s11, 12288
    v_mfma_f32_16x16x32_bf16 v[120:123], a[192:195], a[216:219], v[120:123]
    s_add_u32 s12, s12, 57856
    s_lshr_b32 s23, s85, 5
    s_min_u32 s23, s23, 43008
    s_waitcnt lgkmcnt(15)
    v_mfma_f32_16x16x32_bf16 v[124:127], a[192:195], a[220:223], v[124:127]
    ds_read_b128 a[192:195], v13 offset:2176
    v_mfma_f32_16x16x32_bf16 v[108:111], a[188:191], a[208:211], v[108:111]
    s_add_u32 m0, s47, 0
    s_waitcnt lgkmcnt(15)
    buffer_load_dwordx4 v38, s[64:67], s86 offen offset:0 lds
    v_mfma_f32_16x16x32_bf16 v[112:115], a[188:191], a[212:215], v[112:115]
    v_lshl_add_u32 v56, v1, 3, s12
    s_lshl_b32 s12, s39, 2
    v_mfma_f32_16x16x32_bf16 v[116:119], a[188:191], a[216:219], v[116:119]
    s_waitcnt vmcnt(10)
    buffer_load_dwordx4 v39, s[64:67], s86 offen offset:1024 lds
    s_lshr_b32 s24, s86, 5
    s_min_u32 s24, s24, 43008
    v_mfma_f32_16x16x32_bf16 v[120:123], a[188:191], a[220:223], v[120:123]
    ds_read_b64_tr_b16 a[64:65], v46 offset:49664
    s_add_u32 s11, s11, s12
    v_mfma_f32_16x16x32_bf16 v[124:127], a[188:191], a[224:227], v[124:127]
    ds_read_b128 a[188:191], v13 offset:1664
    s_mul_i32 s11, s11, 44032
    v_mfma_f32_16x16x32_bf16 v[104:107], a[184:187], a[208:211], v[104:107]
    ds_read_b64_tr_b16 a[66:67], v46 offset:51712
    s_lshr_b32 s25, s87, 5
    s_min_u32 s25, s25, 43008
    v_mfma_f32_16x16x32_bf16 v[108:111], a[184:187], a[212:215], v[108:111]
    s_add_u32 s11, s11, 2359296
    buffer_load_dwordx4 v40, s[64:67], s86 offen offset:2048 lds
    v_mfma_f32_16x16x32_bf16 v[112:115], a[184:187], a[216:219], v[112:115]
    ds_read_b64_tr_b16 a[68:69], v47 offset:49664
    v_add_u32 v52, s11, v11
    v_mfma_f32_16x16x32_bf16 v[116:119], a[184:187], a[220:223], v[116:119]
    ds_read_b64_tr_b16 a[70:71], v47 offset:51712
    v_mfma_f32_16x16x32_bf16 v[120:123], a[184:187], a[224:227], v[120:123]
    s_add_u32 s11, s36, 4
    s_lshr_b32 s26, s88, 5
    s_min_u32 s26, s26, 43008
    v_mfma_f32_16x16x32_bf16 v[124:127], a[184:187], a[228:231], v[124:127]
    ds_read_b128 a[184:187], v13 offset:1152
    v_mfma_f32_16x16x32_bf16 v[100:103], a[180:183], a[208:211], v[100:103]
    ds_read_b64_tr_b16 a[72:73], v48 offset:49664
    s_and_b32 s11, s11, 3
    v_mfma_f32_16x16x32_bf16 v[104:107], a[180:183], a[212:215], v[104:107]
    ds_read_b64_tr_b16 a[74:75], v48 offset:51712
    s_mul_i32 s12, s11, 12288
    v_mfma_f32_16x16x32_bf16 v[108:111], a[180:183], a[216:219], v[108:111]
    buffer_load_dwordx4 v41, s[64:67], s86 offen offset:3072 lds
    s_lshr_b32 s27, s89, 5
    s_min_u32 s27, s27, 43008
    v_mfma_f32_16x16x32_bf16 v[112:115], a[180:183], a[220:223], v[112:115]
    ds_read_b64_tr_b16 a[76:77], v49 offset:49664
    s_add_u32 s12, s12, 49664
    v_mfma_f32_16x16x32_bf16 v[116:119], a[180:183], a[224:227], v[116:119]
    ds_read_b64_tr_b16 a[78:79], v49 offset:51712
    v_lshl_add_u32 v22, v1, 3, s12
    v_mfma_f32_16x16x32_bf16 v[120:123], a[180:183], a[228:231], v[120:123]
    s_add_u32 m0, s47, 4096
    s_waitcnt lgkmcnt(11)
    buffer_load_dwordx4 v38, s[64:67], s87 offen offset:0 lds
    v_mfma_f32_16x16x32_bf16 v[124:127], a[180:183], a[232:235], v[124:127]
    ds_read_b128 a[180:183], v13 offset:640
    s_waitcnt vmcnt(9)
    s_lshl_b32 s12, s39, 2
    v_mfma_f32_16x16x32_bf16 v[96:99], a[176:179], a[208:211], v[96:99]
    ds_read_b128 a[208:211], v14 offset:3712
    s_add_u32 s11, s11, s12
    v_mfma_f32_16x16x32_bf16 v[100:103], a[176:179], a[212:215], v[100:103]
    ds_read_b128 a[212:215], v14 offset:3200
    ds_read_b64_tr_b16 a[80:81], v46 offset:33280
    v_mfma_f32_16x16x32_bf16 v[104:107], a[176:179], a[216:219], v[104:107]
    ds_read_b128 a[216:219], v14 offset:2688
    s_mul_i32 s11, s11, 44032
    v_mfma_f32_16x16x32_bf16 v[108:111], a[176:179], a[220:223], v[108:111]
    ds_read_b128 a[220:223], v14 offset:2176
    ds_read_b64_tr_b16 a[82:83], v46 offset:35328
    buffer_load_dwordx4 v39, s[64:67], s87 offen offset:1024 lds
    v_mfma_f32_16x16x32_bf16 v[112:115], a[176:179], a[224:227], v[112:115]
    ds_read_b128 a[224:227], v14 offset:1664
    s_add_u32 s11, s11, 2359296
    v_mfma_f32_16x16x32_bf16 v[116:119], a[176:179], a[228:231], v[116:119]
    ds_read_b128 a[228:231], v14 offset:1152
    ds_read_b64_tr_b16 a[84:85], v47 offset:33280
    v_mfma_f32_16x16x32_bf16 v[120:123], a[176:179], a[232:235], v[120:123]
    ds_read_b128 a[232:235], v14 offset:640
    ds_read_b64_tr_b16 a[86:87], v47 offset:35328
    buffer_load_dwordx4 v40, s[64:67], s87 offen offset:2048 lds
    v_add_u32 v53, s11, v11
    v_mfma_f32_16x16x32_bf16 v[124:127], a[176:179], a[236:239], v[124:127]
    ds_read_b128 a[236:239], v14 offset:128
    ds_read_b128 a[176:179], v13 offset:128
    s_waitcnt lgkmcnt(12)
    v_mfma_f32_16x16x32_bf16 v[124:127], a[204:207], a[208:211], v[124:127]
    ds_read_b64_tr_b16 a[88:89], v48 offset:33280
    v_lshrrev_b32 v2, 1, v9
    v_mfma_f32_16x16x32_bf16 v[120:123], a[200:203], a[208:211], v[120:123]
    ds_read_b128 a[204:207], v13 offset:3776
    v_lshrrev_b32 v3, 1, v10
    s_waitcnt lgkmcnt(13)
    v_mfma_f32_16x16x32_bf16 v[124:127], a[200:203], a[212:215], v[124:127]
    ds_read_b64_tr_b16 a[90:91], v48 offset:35328
    buffer_load_dwordx4 v41, s[64:67], s87 offen offset:3072 lds
    v_mfma_f32_16x16x32_bf16 v[116:119], a[196:199], a[208:211], v[116:119]
    ds_read_b128 a[200:203], v13 offset:3264
    ds_read_b64_tr_b16 a[92:93], v49 offset:33280
    v_xor_b32 v2, v2, v3
    v_mfma_f32_16x16x32_bf16 v[120:123], a[196:199], a[212:215], v[120:123]
    v_lshlrev_b32 v2, 4, v2
    s_waitcnt lgkmcnt(14)
    v_mfma_f32_16x16x32_bf16 v[124:127], a[196:199], a[216:219], v[124:127]
    ds_read_b64_tr_b16 a[94:95], v49 offset:35328
    v_mfma_f32_16x16x32_bf16 v[112:115], a[192:195], a[208:211], v[112:115]
    ds_read_b128 a[196:199], v13 offset:2752
    s_add_u32 m0, s32, 49664
    s_nop 0
    buffer_load_dwordx4 v38, s[64:67], s88 offen offset:0 lds
    v_lshl_add_u32 v2, v9, 7, v2
    v_mfma_f32_16x16x32_bf16 v[116:119], a[192:195], a[212:215], v[116:119]
    s_waitcnt vmcnt(9)
    v_and_b32 v4, 1, v10
    v_mfma_f32_16x16x32_bf16 v[120:123], a[192:195], a[216:219], v[120:123]
    ds_read_b64_tr_b16 a[96:97], v42 offset:8192
    s_waitcnt lgkmcnt(15)
    v_mfma_f32_16x16x32_bf16 v[124:127], a[192:195], a[220:223], v[124:127]
    v_lshl_add_u32 v2, v4, 3, v2
    v_mfma_f32_16x16x32_bf16 v[108:111], a[188:191], a[208:211], v[108:111]
    ds_read_b128 a[192:195], v13 offset:2240
    ds_read_b64_tr_b16 a[98:99], v42 offset:10240
    buffer_load_dwordx4 v39, s[64:67], s88 offen offset:1024 lds
    v_mfma_f32_16x16x32_bf16 v[112:115], a[188:191], a[212:215], v[112:115]
    v_add_u32 v57, s47, v2
    ds_read_b64_tr_b16 a[100:101], v43 offset:8192
    v_mfma_f32_16x16x32_bf16 v[116:119], a[188:191], a[216:219], v[116:119]
    v_xor_b32 v58, 32, v57
    ds_read_b64_tr_b16 a[102:103], v43 offset:10240
    v_mfma_f32_16x16x32_bf16 v[120:123], a[188:191], a[220:223], v[120:123]
    buffer_load_dwordx4 v40, s[64:67], s88 offen offset:2048 lds
    s_waitcnt lgkmcnt(15)
    v_mfma_f32_16x16x32_bf16 v[124:127], a[188:191], a[224:227], v[124:127]
    v_xor_b32 v59, 64, v57
    v_mfma_f32_16x16x32_bf16 v[104:107], a[184:187], a[208:211], v[104:107]
    ds_read_b128 a[188:191], v13 offset:1728
    ds_read_b64_tr_b16 a[104:105], v44 offset:8192
    v_xor_b32 v60, 96, v57
    v_mfma_f32_16x16x32_bf16 v[108:111], a[184:187], a[212:215], v[108:111]
    ds_read_b64_tr_b16 a[106:107], v44 offset:10240
    s_lshl_b32 s11, s44, 9
    v_mfma_f32_16x16x32_bf16 v[112:115], a[184:187], a[216:219], v[112:115]
    ds_read_b64_tr_b16 a[108:109], v45 offset:8192
    s_add_u32 s11, s11, 11403280
    v_mfma_f32_16x16x32_bf16 v[116:119], a[184:187], a[220:223], v[116:119]
    buffer_load_dwordx4 v41, s[64:67], s88 offen offset:3072 lds
    v_mfma_f32_16x16x32_bf16 v[120:123], a[184:187], a[224:227], v[120:123]
    ds_read_b64_tr_b16 a[110:111], v45 offset:10240
    v_mfma_f32_16x16x32_bf16 v[124:127], a[184:187], a[228:231], v[124:127]
    v_lshl_add_u32 v23, v9, 5, s11
    v_mfma_f32_16x16x32_bf16 v[100:103], a[180:183], a[208:211], v[100:103]
    ds_read_b128 a[184:187], v13 offset:1216
    v_mfma_f32_16x16x32_bf16 v[104:107], a[180:183], a[212:215], v[104:107]
    s_add_u32 m0, s32, 33280
    s_waitcnt lgkmcnt(12)
    buffer_load_dwordx4 v38, s[64:67], s89 offen offset:0 lds
    v_mfma_f32_16x16x32_bf16 v[108:111], a[180:183], a[216:219], v[108:111]
    buffer_load_dwordx4 v39, s[64:67], s89 offen offset:1024 lds
    v_mfma_f32_16x16x32_bf16 v[112:115], a[180:183], a[220:223], v[112:115]
    s_waitcnt vmcnt(10)
    v_mfma_f32_16x16x32_bf16 v[116:119], a[180:183], a[224:227], v[116:119]
    ds_read_b64_tr_b16 a[112:113], v42 offset:0
    v_mfma_f32_16x16x32_bf16 v[120:123], a[180:183], a[228:231], v[120:123]
    v_mfma_f32_16x16x32_bf16 v[124:127], a[180:183], a[232:235], v[124:127]
    ds_read_b128 a[180:183], v13 offset:704
    v_mfma_f32_16x16x32_bf16 v[96:99], a[176:179], a[208:211], v[96:99]
    ds_read_b128 a[208:211], v14 offset:3776
    ds_read_b64_tr_b16 a[114:115], v42 offset:2048
    v_mfma_f32_16x16x32_bf16 v[100:103], a[176:179], a[212:215], v[100:103]
    ds_read_b128 a[212:215], v14 offset:3264
    v_mfma_f32_16x16x32_bf16 v[104:107], a[176:179], a[216:219], v[104:107]
    ds_read_b128 a[216:219], v14 offset:2752
    ds_read_b64_tr_b16 a[116:117], v43 offset:0
    buffer_load_dwordx4 v40, s[64:67], s89 offen offset:2048 lds
    v_mfma_f32_16x16x32_bf16 v[108:111], a[176:179], a[220:223], v[108:111]
    ds_read_b128 a[220:223], v14 offset:2240
    ds_read_b64_tr_b16 a[118:119], v43 offset:2048
    v_mfma_f32_16x16x32_bf16 v[112:115], a[176:179], a[224:227], v[112:115]
    ds_read_b128 a[224:227], v14 offset:1728
    v_mfma_f32_16x16x32_bf16 v[116:119], a[176:179], a[228:231], v[116:119]
    ds_read_b128 a[228:231], v14 offset:1216
    ds_read_b64_tr_b16 a[120:121], v44 offset:0
    v_mfma_f32_16x16x32_bf16 v[120:123], a[176:179], a[232:235], v[120:123]
    ds_read_b128 a[232:235], v14 offset:704
    buffer_load_dwordx4 v41, s[64:67], s89 offen offset:3072 lds
    v_mfma_f32_16x16x32_bf16 v[124:127], a[176:179], a[236:239], v[124:127]
    ds_read_b128 a[236:239], v14 offset:192
    ds_read_b128 a[176:179], v13 offset:192
    ds_read_b64_tr_b16 a[122:123], v44 offset:2048
    s_waitcnt lgkmcnt(13)
    v_mfma_f32_16x16x32_bf16 v[124:127], a[204:207], a[208:211], v[124:127]
    ds_read_b64_tr_b16 a[124:125], v45 offset:0
    v_mfma_f32_16x16x32_bf16 v[120:123], a[200:203], a[208:211], v[120:123]
    ds_read_b64_tr_b16 a[126:127], v45 offset:2048
    s_waitcnt lgkmcnt(13)
    v_mfma_f32_16x16x32_bf16 v[124:127], a[200:203], a[212:215], v[124:127]
    v_mfma_f32_16x16x32_bf16 v[116:119], a[196:199], a[208:211], v[116:119]
    s_waitcnt vmcnt(8)
    v_mfma_f32_16x16x32_bf16 v[120:123], a[196:199], a[212:215], v[120:123]
    ds_read_b64_tr_b16 a[128:129], v42 offset:4096
    s_waitcnt lgkmcnt(13)
    v_mfma_f32_16x16x32_bf16 v[124:127], a[196:199], a[216:219], v[124:127]
    v_mfma_f32_16x16x32_bf16 v[112:115], a[192:195], a[208:211], v[112:115]
    ds_read_b64_tr_b16 a[130:131], v42 offset:6144
    v_mfma_f32_16x16x32_bf16 v[116:119], a[192:195], a[212:215], v[116:119]
    v_mfma_f32_16x16x32_bf16 v[120:123], a[192:195], a[216:219], v[120:123]
    buffer_load_dwordx2 v[62:63], v20, s[76:79], 0 offen sc1
    s_waitcnt lgkmcnt(12)
    v_mfma_f32_16x16x32_bf16 v[124:127], a[192:195], a[220:223], v[124:127]
    ds_read_b64_tr_b16 a[132:133], v43 offset:4096
    v_mfma_f32_16x16x32_bf16 v[108:111], a[188:191], a[208:211], v[108:111]
    ds_read_b64_tr_b16 a[134:135], v43 offset:6144
    v_mfma_f32_16x16x32_bf16 v[112:115], a[188:191], a[212:215], v[112:115]
    ds_read_b64_tr_b16 a[136:137], v44 offset:4096
    v_mfma_f32_16x16x32_bf16 v[116:119], a[188:191], a[216:219], v[116:119]
    v_mfma_f32_16x16x32_bf16 v[120:123], a[188:191], a[220:223], v[120:123]
    ds_read_b64_tr_b16 a[138:139], v44 offset:6144
    s_waitcnt lgkmcnt(14)
    v_mfma_f32_16x16x32_bf16 v[124:127], a[188:191], a[224:227], v[124:127]
    ds_read_b64_tr_b16 a[140:141], v45 offset:4096
    v_mfma_f32_16x16x32_bf16 v[104:107], a[184:187], a[208:211], v[104:107]
    v_mfma_f32_16x16x32_bf16 v[108:111], a[184:187], a[212:215], v[108:111]
    ds_read_b64_tr_b16 a[142:143], v45 offset:6144
    v_mfma_f32_16x16x32_bf16 v[112:115], a[184:187], a[216:219], v[112:115]
    v_mfma_f32_16x16x32_bf16 v[116:119], a[184:187], a[220:223], v[116:119]
    s_waitcnt vmcnt(5)
    v_mfma_f32_16x16x32_bf16 v[120:123], a[184:187], a[224:227], v[120:123]
    ds_read_b64_tr_b16 a[144:145], v46 offset:49664
    s_waitcnt lgkmcnt(15)
    v_mfma_f32_16x16x32_bf16 v[124:127], a[184:187], a[228:231], v[124:127]
    v_mfma_f32_16x16x32_bf16 v[100:103], a[180:183], a[208:211], v[100:103]
    ds_read_b64_tr_b16 a[146:147], v46 offset:51712
    v_mfma_f32_16x16x32_bf16 v[104:107], a[180:183], a[212:215], v[104:107]
    v_mfma_f32_16x16x32_bf16 v[108:111], a[180:183], a[216:219], v[108:111]
    ds_read_b64_tr_b16 a[148:149], v47 offset:49664
    v_mfma_f32_16x16x32_bf16 v[112:115], a[180:183], a[220:223], v[112:115]
    ds_read_b64_tr_b16 a[150:151], v47 offset:51712
    v_mfma_f32_16x16x32_bf16 v[116:119], a[180:183], a[224:227], v[116:119]
    v_mfma_f32_16x16x32_bf16 v[120:123], a[180:183], a[228:231], v[120:123]
    ds_read_b64_tr_b16 a[152:153], v48 offset:49664
    s_waitcnt lgkmcnt(15)
    v_mfma_f32_16x16x32_bf16 v[124:127], a[180:183], a[232:235], v[124:127]
    v_mfma_f32_16x16x32_bf16 v[96:99], a[176:179], a[208:211], v[96:99]
    ds_read_b64_tr_b16 a[154:155], v48 offset:51712
    v_mfma_f32_16x16x32_bf16 v[100:103], a[176:179], a[212:215], v[100:103]
    ds_read_b64_tr_b16 a[156:157], v49 offset:49664
    v_mfma_f32_16x16x32_bf16 v[104:107], a[176:179], a[216:219], v[104:107]
    s_waitcnt vmcnt(0)
    v_cmp_ne_u64 vcc, s[0:1], v[62:63]
    s_mov_b64 s[16:17], s[76:77]
    s_mov_b32 s19, 0x00020000
    s_cmp_eq_u64 vcc, 0
    s_cselect_b32 s18, 13631488, 0
    v_mfma_f32_16x16x32_bf16 v[108:111], a[176:179], a[220:223], v[108:111]
    ds_read_b64_tr_b16 a[158:159], v49 offset:51712
    v_mfma_f32_16x16x32_bf16 v[112:115], a[176:179], a[224:227], v[112:115]
    buffer_load_dwordx4 v[160:163], v50, s[16:19], s9 offen sc1
    v_mfma_f32_16x16x32_bf16 v[116:119], a[176:179], a[228:231], v[116:119]
    v_mfma_f32_16x16x32_bf16 v[120:123], a[176:179], a[232:235], v[120:123]
    buffer_load_dwordx2 v[62:63], v20, s[76:79], 0 offen sc1
    v_mfma_f32_16x16x32_bf16 v[124:127], a[176:179], a[236:239], v[124:127]
    buffer_load_dwordx4 v[164:167], v51, s[16:19], s9 offen sc1
    s_waitcnt lgkmcnt(0)
    s_cmp_lg_u32 s8, 0
    s_cbranch_scc1 L_odd1
    ds_write_b128 v12, v[112:115] offset:0
    ds_write_b128 v12, v[116:119] offset:1024
    ds_write_b128 v12, v[120:123] offset:2048
    s_nop 0
    ds_write_b128 v12, v[124:127] offset:3072
    s_branch L_j1
L_odd1:
    s_nop 4
    ds_write_b128 v12, v[96:99] offset:0
    ds_write_b128 v12, v[100:103] offset:1024
    ds_write_b128 v12, v[104:107] offset:2048
    ds_write_b128 v12, v[108:111] offset:3072
    s_waitcnt lgkmcnt(0)
    v_pk_mov_b32 v[96:97], v[112:113], v[112:113] op_sel:[0,1]
    v_pk_mov_b32 v[98:99], v[114:115], v[114:115] op_sel:[0,1]
    v_pk_mov_b32 v[100:101], v[116:117], v[116:117] op_sel:[0,1]
    v_pk_mov_b32 v[102:103], v[118:119], v[118:119] op_sel:[0,1]
    v_pk_mov_b32 v[104:105], v[120:121], v[120:121] op_sel:[0,1]
    v_pk_mov_b32 v[106:107], v[122:123], v[122:123] op_sel:[0,1]
    v_pk_mov_b32 v[108:109], v[124:125], v[124:125] op_sel:[0,1]
    v_pk_mov_b32 v[110:111], v[126:127], v[126:127] op_sel:[0,1]
L_j1:
    buffer_load_dwordx4 v[168:171], v52, s[16:19], s9 offen sc1
    s_waitcnt lgkmcnt(0)
    s_barrier
    ds_read_b128 v[72:75], v15 offset:0
    ds_read_b128 v[76:79], v15 offset:1024
    ds_read_b128 v[80:83], v15 offset:2048
    ds_read_b128 v[84:87], v15 offset:3072
    buffer_load_dwordx4 v[172:175], v53, s[16:19], s9 offen sc1
    buffer_load_dwordx4 v[176:179], v50, s[16:19], s14 offen sc1
    s_waitcnt lgkmcnt(3)
    v_pk_add_f32 v[96:97], v[96:97], v[72:73]
    v_pk_add_f32 v[98:99], v[98:99], v[74:75]
    v_cvt_pk_bf16_f32 v88, v96, v97
    v_cvt_pk_bf16_f32 v89, v98, v99
    ds_write_b64 v16, v[88:89] offset:4096
    s_waitcnt lgkmcnt(3)
    v_pk_add_f32 v[100:101], v[100:101], v[76:77]
    v_pk_add_f32 v[102:103], v[102:103], v[78:79]
    v_cvt_pk_bf16_f32 v90, v100, v101
    v_cvt_pk_bf16_f32 v91, v102, v103
    ds_write_b64 v16, v[90:91] offset:4608
    ds_read_b128 v[64:67], v12 offset:4096
    s_waitcnt lgkmcnt(4)
    v_pk_add_f32 v[104:105], v[104:105], v[80:81]
    v_pk_add_f32 v[106:107], v[106:107], v[82:83]
    v_cvt_pk_bf16_f32 v92, v104, v105
    v_cvt_pk_bf16_f32 v93, v106, v107
    ds_write_b64 v16, v[92:93] offset:5120
    s_waitcnt lgkmcnt(4)
    v_pk_add_f32 v[108:109], v[108:109], v[84:85]
    v_pk_add_f32 v[110:111], v[110:111], v[86:87]
    v_cvt_pk_bf16_f32 v94, v108, v109
    v_cvt_pk_bf16_f32 v95, v110, v111
    ds_write_b64 v16, v[94:95] offset:5632
    ds_read_b128 v[68:71], v12 offset:5120
    buffer_load_dwordx4 v[180:183], v51, s[16:19], s14 offen sc1
    s_waitcnt lgkmcnt(3)
    buffer_store_dwordx4 v[64:67], v11, s[76:79], s53 offen sc1
    s_waitcnt lgkmcnt(0)
    buffer_store_dwordx4 v[68:71], v11, s[76:79], s53 offen offset:1024 sc1
    buffer_load_dwordx4 v[184:187], v52, s[16:19], s14 offen sc1
    s_cmp_lg_u32 s18, 0
    s_cbranch_scc1 L_haveH
    s_waitcnt vmcnt(8)
    v_cmp_ne_u64 vcc, s[0:1], v[62:63]
    s_nop 0
    s_cmp_eq_u64 vcc, 0
    s_cbranch_scc0 L_pf2
L_pf2_ok:
    buffer_load_dwordx4 v[160:163], v50, s[76:79], s9 offen sc1
    buffer_load_dwordx4 v[164:167], v51, s[76:79], s9 offen sc1
    buffer_load_dwordx4 v[168:171], v52, s[76:79], s9 offen sc1
    buffer_load_dwordx4 v[172:175], v53, s[76:79], s9 offen sc1
    buffer_load_dwordx4 v[176:179], v50, s[76:79], s14 offen sc1
    buffer_load_dwordx4 v[180:183], v51, s[76:79], s14 offen sc1
    buffer_load_dwordx4 v[184:187], v52, s[76:79], s14 offen sc1
L_haveH:
    s_waitcnt vmcnt(11)
    buffer_load_dwordx4 v[188:191], v53, s[76:79], s14 offen sc1
    ds_read_b64_tr_b16 a[160:161], v46 offset:33280
    buffer_load_dwordx4 v[192:195], v50, s[76:79], s15 offen sc1
    ds_read_b64_tr_b16 a[162:163], v46 offset:35328
    buffer_load_dwordx4 v[196:199], v50, s[76:79], s20 offen sc1
    ds_read_b64_tr_b16 a[164:165], v47 offset:33280
    buffer_load_dwordx4 v[200:203], v50, s[76:79], s21 offen sc1
    ds_read_b64_tr_b16 a[166:167], v47 offset:35328
    ds_read_b64_tr_b16 a[168:169], v48 offset:33280
    buffer_load_dwordx4 v[204:207], v50, s[76:79], s22 offen sc1
    ds_read_b64_tr_b16 a[170:171], v48 offset:35328
    buffer_load_dwordx4 v[208:211], v50, s[76:79], s23 offen sc1
    ds_read_b64_tr_b16 a[172:173], v49 offset:33280
    buffer_load_dwordx4 v[212:215], v50, s[76:79], s24 offen sc1
    ds_read_b64_tr_b16 a[174:175], v49 offset:35328
    s_cmp_lg_u32 s18, 0
    s_cbranch_scc1 L_lateok
    s_waitcnt vmcnt(7)
L_lateok:
    s_waitcnt vmcnt(16)
    v_mfma_f32_16x16x32_bf16 v[72:75], a[0:3], v[160:163], 0
    buffer_load_dwordx4 v[216:219], v50, s[76:79], s25 offen sc1
    v_mfma_f32_16x16x32_bf16 v[76:79], a[4:7], v[160:163], 0
    v_mfma_f32_16x16x32_bf16 v[80:83], a[8:11], v[160:163], 0
    v_mfma_f32_16x16x32_bf16 v[84:87], a[12:15], v[160:163], 0
    buffer_load_dwordx4 v[220:223], v50, s[76:79], s26 offen sc1
    s_waitcnt vmcnt(13)
    v_mfma_f32_16x16x32_bf16 v[72:75], a[16:19], v[176:179], v[72:75]
    v_mfma_f32_16x16x32_bf16 v[76:79], a[20:23], v[176:179], v[76:79]
    v_mfma_f32_16x16x32_bf16 v[80:83], a[24:27], v[176:179], v[80:83]
    v_mfma_f32_16x16x32_bf16 v[84:87], a[28:31], v[176:179], v[84:87]
    buffer_load_dwordx4 v[224:227], v50, s[76:79], s27 offen sc1
    s_waitcnt vmcnt(8)
    v_mfma_f32_16x16x32_bf16 v[72:75], a[32:35], v[192:195], v[72:75]
    v_mfma_f32_16x16x32_bf16 v[76:79], a[36:39], v[192:195], v[76:79]
    v_mfma_f32_16x16x32_bf16 v[80:83], a[40:43], v[192:195], v[80:83]
    v_mfma_f32_16x16x32_bf16 v[84:87], a[44:47], v[192:195], v[84:87]
    buffer_load_dwordx4 v[228:231], v51, s[76:79], s15 offen sc1
    s_waitcnt vmcnt(8)
    v_mfma_f32_16x16x32_bf16 v[72:75], a[48:51], v[196:199], v[72:75]
    v_mfma_f32_16x16x32_bf16 v[76:79], a[52:55], v[196:199], v[76:79]
    v_mfma_f32_16x16x32_bf16 v[80:83], a[56:59], v[196:199], v[80:83]
    buffer_load_dwordx4 v[232:235], v51, s[76:79], s20 offen sc1
    v_mfma_f32_16x16x32_bf16 v[84:87], a[60:63], v[196:199], v[84:87]
    s_waitcnt vmcnt(8)
    v_mfma_f32_16x16x32_bf16 v[72:75], a[64:67], v[200:203], v[72:75]
    v_mfma_f32_16x16x32_bf16 v[76:79], a[68:71], v[200:203], v[76:79]
    v_mfma_f32_16x16x32_bf16 v[80:83], a[72:75], v[200:203], v[80:83]
    buffer_load_dwordx4 v[236:239], v51, s[76:79], s21 offen sc1
    v_mfma_f32_16x16x32_bf16 v[84:87], a[76:79], v[200:203], v[84:87]
    s_waitcnt vmcnt(8)
    v_mfma_f32_16x16x32_bf16 v[72:75], a[80:83], v[204:207], v[72:75]
    v_mfma_f32_16x16x32_bf16 v[76:79], a[84:87], v[204:207], v[76:79]
    v_mfma_f32_16x16x32_bf16 v[80:83], a[88:91], v[204:207], v[80:83]
    s_add_u32 m0, s47, 6144
    s_nop 0
    buffer_load_dwordx4 v34, s[68:71], s46 offen lds
    v_mfma_f32_16x16x32_bf16 v[84:87], a[92:95], v[204:207], v[84:87]
    s_waitcnt vmcnt(8)
    v_mfma_f32_16x16x32_bf16 v[72:75], a[96:99], v[208:211], v[72:75]
    v_mfma_f32_16x16x32_bf16 v[76:79], a[100:103], v[208:211], v[76:79]
    buffer_load_dwordx4 v35, s[68:71], s46 offen offset:1024 lds
    v_mfma_f32_16x16x32_bf16 v[80:83], a[104:107], v[208:211], v[80:83]
    v_mfma_f32_16x16x32_bf16 v[84:87], a[108:111], v[208:211], v[84:87]
    s_waitcnt vmcnt(8)
    v_mfma_f32_16x16x32_bf16 v[72:75], a[112:115], v[212:215], v[72:75]
    v_mfma_f32_16x16x32_bf16 v[76:79], a[116:119], v[212:215], v[76:79]
    buffer_load_dwordx4 v[38:41], v23, s[76:79], 0 offen sc1
    v_mfma_f32_16x16x32_bf16 v[80:83], a[120:123], v[212:215], v[80:83]
    v_mfma_f32_16x16x32_bf16 v[84:87], a[124:127], v[212:215], v[84:87]
    s_waitcnt vmcnt(8)
    v_mfma_f32_16x16x32_bf16 v[72:75], a[128:131], v[216:219], v[72:75]
    v_mfma_f32_16x16x32_bf16 v[76:79], a[132:135], v[216:219], v[76:79]
    buffer_load_dwordx4 v[240:243], v51, s[76:79], s22 offen sc1
    v_mfma_f32_16x16x32_bf16 v[80:83], a[136:139], v[216:219], v[80:83]
    s_mov_b64 exec, 15
    buffer_store_dwordx4 v[30:33], v11, s[76:79], s52 offen sc1
    s_mov_b64 exec, -1
    v_mfma_f32_16x16x32_bf16 v[84:87], a[140:143], v[216:219], v[84:87]
    s_waitcnt vmcnt(9)
    v_mfma_f32_16x16x32_bf16 v[72:75], a[144:147], v[220:223], v[72:75]
    v_mfma_f32_16x16x32_bf16 v[76:79], a[148:151], v[220:223], v[76:79]
    buffer_load_dwordx4 v[244:247], v51, s[76:79], s23 offen sc1
    v_mfma_f32_16x16x32_bf16 v[80:83], a[152:155], v[220:223], v[80:83]
    v_mfma_f32_16x16x32_bf16 v[84:87], a[156:159], v[220:223], v[84:87]
    s_waitcnt vmcnt(9) lgkmcnt(0)
    v_mfma_f32_16x16x32_bf16 v[72:75], a[160:163], v[224:227], v[72:75]
    buffer_load_dwordx4 v[248:251], v51, s[76:79], s24 offen sc1
    v_mfma_f32_16x16x32_bf16 v[76:79], a[164:167], v[224:227], v[76:79]
    v_mfma_f32_16x16x32_bf16 v[80:83], a[168:171], v[224:227], v[80:83]
    v_mfma_f32_16x16x32_bf16 v[84:87], a[172:175], v[224:227], v[84:87]
    v_mfma_f32_16x16x32_bf16 v[88:91], a[0:3], v[164:167], 0
    buffer_load_dwordx4 v[252:255], v51, s[76:79], s25 offen sc1
    v_mfma_f32_16x16x32_bf16 v[92:95], a[4:7], v[164:167], 0
    v_mfma_f32_16x16x32_bf16 v[96:99], a[8:11], v[164:167], 0
    v_mfma_f32_16x16x32_bf16 v[100:103], a[12:15], v[164:167], 0
    v_mfma_f32_16x16x32_bf16 v[88:91], a[16:19], v[180:183], v[88:91]
    ds_write_b64 v54, v[72:73] offset:0
    v_mfma_f32_16x16x32_bf16 v[92:95], a[20:23], v[180:183], v[92:95]
    buffer_load_dwordx4 a[176:179], v51, s[76:79], s26 offen sc1
    v_mfma_f32_16x16x32_bf16 v[96:99], a[24:27], v[180:183], v[96:99]
    ds_write_b64 v54, v[74:75] offset:512
    v_mfma_f32_16x16x32_bf16 v[100:103], a[28:31], v[180:183], v[100:103]
    buffer_load_dwordx4 a[180:183], v51, s[76:79], s27 offen sc1
    s_waitcnt vmcnt(12)
    v_mfma_f32_16x16x32_bf16 v[88:91], a[32:35], v[228:231], v[88:91]
    v_mfma_f32_16x16x32_bf16 v[92:95], a[36:39], v[228:231], v[92:95]
    ds_write_b64 v54, v[76:77] offset:1024
    v_mfma_f32_16x16x32_bf16 v[96:99], a[40:43], v[228:231], v[96:99]
    v_mfma_f32_16x16x32_bf16 v[100:103], a[44:47], v[228:231], v[100:103]
    buffer_load_dwordx4 a[184:187], v52, s[76:79], s15 offen sc1
    s_waitcnt vmcnt(12)
    v_mfma_f32_16x16x32_bf16 v[88:91], a[48:51], v[232:235], v[88:91]
    ds_write_b64 v54, v[78:79] offset:1536
    v_mfma_f32_16x16x32_bf16 v[92:95], a[52:55], v[232:235], v[92:95]
    v_mfma_f32_16x16x32_bf16 v[96:99], a[56:59], v[232:235], v[96:99]
    v_mfma_f32_16x16x32_bf16 v[100:103], a[60:63], v[232:235], v[100:103]
    ds_write_b64 v54, v[80:81] offset:2048
    s_waitcnt vmcnt(11)
    v_mfma_f32_16x16x32_bf16 v[88:91], a[64:67], v[236:239], v[88:91]
    buffer_load_dwordx4 a[188:191], v52, s[76:79], s20 offen sc1
    v_mfma_f32_16x16x32_bf16 v[92:95], a[68:71], v[236:239], v[92:95]
    v_mfma_f32_16x16x32_bf16 v[96:99], a[72:75], v[236:239], v[96:99]
    ds_write_b64 v54, v[82:83] offset:2560
    v_mfma_f32_16x16x32_bf16 v[100:103], a[76:79], v[236:239], v[100:103]
    buffer_load_dwordx4 a[192:195], v52, s[76:79], s21 offen sc1
    s_waitcnt vmcnt(9)
    v_mfma_f32_16x16x32_bf16 v[88:91], a[80:83], v[240:243], v[88:91]
    v_mfma_f32_16x16x32_bf16 v[92:95], a[84:87], v[240:243], v[92:95]
    ds_write_b64 v54, v[84:85] offset:3072
    v_mfma_f32_16x16x32_bf16 v[96:99], a[88:91], v[240:243], v[96:99]
    v_cmp_ne_u64 vcc, s[0:1], v[40:41]
    s_nop 0
    s_cmp_eq_u64 vcc, 0
    s_cbranch_scc0 L_sv
L_sv_ok:
    buffer_load_dwordx4 a[196:199], v52, s[76:79], s22 offen sc1
    v_mfma_f32_16x16x32_bf16 v[100:103], a[92:95], v[240:243], v[100:103]
    s_waitcnt vmcnt(8)
    v_mfma_f32_16x16x32_bf16 v[88:91], a[96:99], v[244:247], v[88:91]
    ds_read_b64 v[104:105], v57 offset:6144
    v_mfma_f32_16x16x32_bf16 v[92:95], a[100:103], v[244:247], v[92:95]
    ds_write_b64 v54, v[86:87] offset:3584
    v_mfma_f32_16x16x32_bf16 v[96:99], a[104:107], v[244:247], v[96:99]
    ds_read_b64 v[106:107], v58 offset:6144
    v_mfma_f32_16x16x32_bf16 v[100:103], a[108:111], v[244:247], v[100:103]
    ds_read_b64 v[108:109], v59 offset:6144
    s_waitcnt vmcnt(7)
    v_mfma_f32_16x16x32_bf16 v[88:91], a[112:115], v[248:251], v[88:91]
    ds_read_b64 v[110:111], v60 offset:6144
    v_mfma_f32_16x16x32_bf16 v[92:95], a[116:119], v[248:251], v[92:95]
    buffer_load_dwordx4 a[200:203], v52, s[76:79], s23 offen sc1
    v_mfma_f32_16x16x32_bf16 v[96:99], a[120:123], v[248:251], v[96:99]
    buffer_load_dwordx4 a[204:207], v52, s[76:79], s24 offen sc1
    v_mfma_f32_16x16x32_bf16 v[100:103], a[124:127], v[248:251], v[100:103]
    s_waitcnt vmcnt(8)
    v_mfma_f32_16x16x32_bf16 v[88:91], a[128:131], v[252:255], v[88:91]
    v_mfma_f32_16x16x32_bf16 v[92:95], a[132:135], v[252:255], v[92:95]
    buffer_load_dwordx4 a[208:211], v52, s[76:79], s25 offen sc1
    v_mfma_f32_16x16x32_bf16 v[96:99], a[136:139], v[252:255], v[96:99]
    s_waitcnt lgkmcnt(0)
    v_lshlrev_b32 v112, 16, v104
    v_mfma_f32_16x16x32_bf16 v[100:103], a[140:143], v[252:255], v[100:103]
    v_and_b32 v113, s48, v104
    s_waitcnt vmcnt(8)
    v_mfma_f32_16x16x32_bf16 v[88:91], a[144:147], a[176:179], v[88:91]
    v_sub_f32 v128, v112, v38
    v_sub_f32 v129, v113, v38
    v_mfma_f32_16x16x32_bf16 v[92:95], a[148:151], a[176:179], v[92:95]
    v_cvt_pk_bf16_f32 v129, v128, v129
    v_lshlrev_b32 v128, 16, v129
    v_mfma_f32_16x16x32_bf16 v[96:99], a[152:155], a[176:179], v[96:99]
    v_and_b32 v129, s48, v129
    buffer_load_dwordx4 a[212:215], v52, s[76:79], s26 offen sc1
    v_mfma_f32_16x16x32_bf16 v[100:103], a[156:159], a[176:179], v[100:103]
    v_mul_f32 v128, v128, v39
    s_waitcnt vmcnt(8)
    v_mfma_f32_16x16x32_bf16 v[88:91], a[160:163], a[180:183], v[88:91]
    v_mul_f32 v129, v129, v39
    v_cvt_pk_bf16_f32 v129, v128, v129
    v_mfma_f32_16x16x32_bf16 v[92:95], a[164:167], a[180:183], v[92:95]
    v_lshlrev_b32 v128, 16, v129
    v_and_b32 v129, s48, v129
    v_mfma_f32_16x16x32_bf16 v[96:99], a[168:171], a[180:183], v[96:99]
    v_lshlrev_b32 v114, 16, v105
    v_and_b32 v115, s48, v105
    v_mfma_f32_16x16x32_bf16 v[100:103], a[172:175], a[180:183], v[100:103]
    buffer_load_dwordx4 a[216:219], v52, s[76:79], s27 offen sc1
    v_mfma_f32_16x16x32_bf16 v[72:75], a[0:3], v[168:171], 0
    v_sub_f32 v130, v114, v38
    v_sub_f32 v131, v115, v38
    v_mfma_f32_16x16x32_bf16 v[76:79], a[4:7], v[168:171], 0
    v_cvt_pk_bf16_f32 v131, v130, v131
    v_lshlrev_b32 v130, 16, v131
    v_mfma_f32_16x16x32_bf16 v[80:83], a[8:11], v[168:171], 0
    v_and_b32 v131, s48, v131
    buffer_load_dwordx4 a[220:223], v53, s[76:79], s15 offen sc1
    v_mfma_f32_16x16x32_bf16 v[84:87], a[12:15], v[168:171], 0
    v_mul_f32 v130, v130, v39
    v_mfma_f32_16x16x32_bf16 v[72:75], a[16:19], v[184:187], v[72:75]
    v_mul_f32 v131, v131, v39
    v_cvt_pk_bf16_f32 v131, v130, v131
    v_mfma_f32_16x16x32_bf16 v[76:79], a[20:23], v[184:187], v[76:79]
    v_lshlrev_b32 v130, 16, v131
    v_and_b32 v131, s48, v131
    v_mfma_f32_16x16x32_bf16 v[80:83], a[24:27], v[184:187], v[80:83]
    ds_write_b64 v55, v[88:89] offset:0
    v_lshlrev_b32 v116, 16, v106
    v_mfma_f32_16x16x32_bf16 v[84:87], a[28:31], v[184:187], v[84:87]
    buffer_load_dwordx4 a[224:227], v53, s[76:79], s20 offen sc1
    v_and_b32 v117, s48, v106
    v_sub_f32 v132, v116, v38
    s_waitcnt vmcnt(10)
    v_mfma_f32_16x16x32_bf16 v[72:75], a[32:35], a[184:187], v[72:75]
    ds_write_b64 v55, v[90:91] offset:512
    v_sub_f32 v133, v117, v38
    v_mfma_f32_16x16x32_bf16 v[76:79], a[36:39], a[184:187], v[76:79]
    v_cvt_pk_bf16_f32 v133, v132, v133
    v_lshlrev_b32 v132, 16, v133
    v_mfma_f32_16x16x32_bf16 v[80:83], a[40:43], a[184:187], v[80:83]
    v_and_b32 v133, s48, v133
    buffer_load_dwordx4 a[228:231], v53, s[76:79], s21 offen sc1
    v_mfma_f32_16x16x32_bf16 v[84:87], a[44:47], a[184:187], v[84:87]
    ds_write_b64 v55, v[92:93] offset:1024
    v_mul_f32 v132, v132, v39
    v_mul_f32 v133, v133, v39
    s_waitcnt vmcnt(10)
    v_mfma_f32_16x16x32_bf16 v[72:75], a[48:51], a[188:191], v[72:75]
    v_cvt_pk_bf16_f32 v133, v132, v133
    v_lshlrev_b32 v132, 16, v133
    v_mfma_f32_16x16x32_bf16 v[76:79], a[52:55], a[188:191], v[76:79]
    v_and_b32 v133, s48, v133
    v_lshlrev_b32 v118, 16, v107
    v_mfma_f32_16x16x32_bf16 v[80:83], a[56:59], a[188:191], v[80:83]
    ds_write_b64 v55, v[94:95] offset:1536
    v_and_b32 v119, s48, v107
    v_mfma_f32_16x16x32_bf16 v[84:87], a[60:63], a[188:191], v[84:87]
    buffer_load_dwordx4 a[232:235], v53, s[76:79], s22 offen sc1
    v_sub_f32 v134, v118, v38
    s_waitcnt vmcnt(10)
    v_mfma_f32_16x16x32_bf16 v[72:75], a[64:67], a[192:195], v[72:75]
    v_sub_f32 v135, v119, v38
    v_cvt_pk_bf16_f32 v135, v134, v135
    v_mfma_f32_16x16x32_bf16 v[76:79], a[68:71], a[192:195], v[76:79]
    ds_write_b64 v55, v[96:97] offset:2048
    v_lshlrev_b32 v134, 16, v135
    v_mfma_f32_16x16x32_bf16 v[80:83], a[72:75], a[192:195], v[80:83]
    buffer_load_dwordx4 a[236:239], v53, s[76:79], s23 offen sc1
    v_and_b32 v135, s48, v135
    v_mul_f32 v134, v134, v39
    v_mfma_f32_16x16x32_bf16 v[84:87], a[76:79], a[192:195], v[84:87]
    v_mul_f32 v135, v135, v39
    v_cvt_pk_bf16_f32 v135, v134, v135
    s_waitcnt vmcnt(10)
    v_mfma_f32_16x16x32_bf16 v[72:75], a[80:83], a[196:199], v[72:75]
    ds_write_b64 v55, v[98:99] offset:2560
    v_lshlrev_b32 v134, 16, v135
    v_mfma_f32_16x16x32_bf16 v[76:79], a[84:87], a[196:199], v[76:79]
    v_and_b32 v135, s48, v135
    v_lshlrev_b32 v120, 16, v108
    v_mfma_f32_16x16x32_bf16 v[80:83], a[88:91], a[196:199], v[80:83]
    buffer_load_dwordx4 a[240:243], v53, s[76:79], s24 offen sc1
    v_and_b32 v121, s48, v108
    v_mfma_f32_16x16x32_bf16 v[84:87], a[92:95], a[196:199], v[84:87]
    ds_write_b64 v55, v[100:101] offset:3072
    v_sub_f32 v136, v120, v38
    v_sub_f32 v137, v121, v38
    s_waitcnt vmcnt(10)
    v_mfma_f32_16x16x32_bf16 v[72:75], a[96:99], a[200:203], v[72:75]
    v_cvt_pk_bf16_f32 v137, v136, v137
    v_lshlrev_b32 v136, 16, v137
    v_mfma_f32_16x16x32_bf16 v[76:79], a[100:103], a[200:203], v[76:79]
    v_and_b32 v137, s48, v137
    buffer_load_dwordx4 a[244:247], v53, s[76:79], s25 offen sc1
    v_mfma_f32_16x16x32_bf16 v[80:83], a[104:107], a[200:203], v[80:83]
    ds_write_b64 v55, v[102:103] offset:3584
    v_mul_f32 v136, v136, v39
    v_mul_f32 v137, v137, v39
    v_mfma_f32_16x16x32_bf16 v[84:87], a[108:111], a[200:203], v[84:87]
    v_cvt_pk_bf16_f32 v137, v136, v137
    s_waitcnt vmcnt(10)
    v_mfma_f32_16x16x32_bf16 v[72:75], a[112:115], a[204:207], v[72:75]
    v_lshlrev_b32 v136, 16, v137
    v_and_b32 v137, s48, v137
    v_mfma_f32_16x16x32_bf16 v[76:79], a[116:119], a[204:207], v[76:79]
    buffer_load_dwordx4 a[248:251], v53, s[76:79], s26 offen sc1
    v_lshlrev_b32 v122, 16, v109
    v_and_b32 v123, s48, v109
    v_mfma_f32_16x16x32_bf16 v[80:83], a[120:123], a[204:207], v[80:83]
    v_sub_f32 v138, v122, v38
    v_sub_f32 v139, v123, v38
    v_mfma_f32_16x16x32_bf16 v[84:87], a[124:127], a[204:207], v[84:87]
    v_cvt_pk_bf16_f32 v139, v138, v139
    s_waitcnt vmcnt(10)
    v_mfma_f32_16x16x32_bf16 v[72:75], a[128:131], a[208:211], v[72:75]
    v_lshlrev_b32 v138, 16, v139
    buffer_load_dwordx4 a[252:255], v53, s[76:79], s27 offen sc1
    v_mfma_f32_16x16x32_bf16 v[76:79], a[132:135], a[208:211], v[76:79]
    v_and_b32 v139, s48, v139
    v_mul_f32 v138, v138, v39
    v_mfma_f32_16x16x32_bf16 v[80:83], a[136:139], a[208:211], v[80:83]
    v_mul_f32 v139, v139, v39
    v_cvt_pk_bf16_f32 v139, v138, v139
    v_mfma_f32_16x16x32_bf16 v[84:87], a[140:143], a[208:211], v[84:87]
    v_lshlrev_b32 v138, 16, v139
    s_waitcnt vmcnt(10)
    v_mfma_f32_16x16x32_bf16 v[72:75], a[144:147], a[212:215], v[72:75]
    v_and_b32 v139, s48, v139
    v_lshlrev_b32 v124, 16, v110
    v_mfma_f32_16x16x32_bf16 v[76:79], a[148:151], a[212:215], v[76:79]
    buffer_load_dwordx2 v[62:63], v21, s[76:79], 0 offen sc1
    v_and_b32 v125, s48, v110
    v_mfma_f32_16x16x32_bf16 v[80:83], a[152:155], a[212:215], v[80:83]
    v_sub_f32 v140, v124, v38
    v_sub_f32 v141, v125, v38
    v_mfma_f32_16x16x32_bf16 v[84:87], a[156:159], a[212:215], v[84:87]
    v_cvt_pk_bf16_f32 v141, v140, v141
    s_waitcnt vmcnt(10)
    v_mfma_f32_16x16x32_bf16 v[72:75], a[160:163], a[216:219], v[72:75]
    v_lshlrev_b32 v140, 16, v141
    v_and_b32 v141, s48, v141
    v_mfma_f32_16x16x32_bf16 v[76:79], a[164:167], a[216:219], v[76:79]
    v_mul_f32 v140, v140, v39
    v_mul_f32 v141, v141, v39
    v_mfma_f32_16x16x32_bf16 v[80:83], a[168:171], a[216:219], v[80:83]
    v_cvt_pk_bf16_f32 v141, v140, v141
    v_lshlrev_b32 v140, 16, v141
    v_mfma_f32_16x16x32_bf16 v[84:87], a[172:175], a[216:219], v[84:87]
    v_and_b32 v141, s48, v141
    v_mfma_f32_16x16x32_bf16 v[88:91], a[0:3], v[172:175], 0
    v_lshlrev_b32 v126, 16, v111
    v_and_b32 v127, s48, v111
    v_mfma_f32_16x16x32_bf16 v[92:95], a[4:7], v[172:175], 0
    v_sub_f32 v142, v126, v38
    v_sub_f32 v143, v127, v38
    v_mfma_f32_16x16x32_bf16 v[96:99], a[8:11], v[172:175], 0
    v_cvt_pk_bf16_f32 v143, v142, v143
    v_lshlrev_b32 v142, 16, v143
    v_mfma_f32_16x16x32_bf16 v[100:103], a[12:15], v[172:175], 0
    ds_write_b64 v56, v[72:73] offset:0
    v_mfma_f32_16x16x32_bf16 v[88:91], a[16:19], v[188:191], v[88:91]
    ds_write_b64 v56, v[74:75] offset:512
    v_and_b32 v143, s48, v143
    v_mul_f32 v142, v142, v39
    v_mfma_f32_16x16x32_bf16 v[92:95], a[20:23], v[188:191], v[92:95]
    ds_write_b64 v56, v[76:77] offset:1024
    v_mul_f32 v143, v143, v39
    v_mfma_f32_16x16x32_bf16 v[96:99], a[24:27], v[188:191], v[96:99]
    ds_write_b64 v56, v[78:79] offset:1536
    v_cvt_pk_bf16_f32 v143, v142, v143
    v_lshlrev_b32 v142, 16, v143
    v_and_b32 v143, s48, v143
    v_mfma_f32_16x16x32_bf16 v[100:103], a[28:31], v[188:191], v[100:103]
    ds_write_b64 v56, v[80:81] offset:2048
    s_waitcnt vmcnt(9)
    v_mfma_f32_16x16x32_bf16 v[88:91], a[32:35], a[220:223], v[88:91]
    ds_write_b64 v56, v[82:83] offset:2560
    v_mfma_f32_16x16x32_bf16 v[92:95], a[36:39], a[220:223], v[92:95]
    ds_write_b64 v56, v[84:85] offset:3072
    v_mfma_f32_16x16x32_bf16 v[96:99], a[40:43], a[220:223], v[96:99]
    ds_write_b64 v56, v[86:87] offset:3584
    v_mfma_f32_16x16x32_bf16 v[100:103], a[44:47], a[220:223], v[100:103]
    s_waitcnt vmcnt(8)
    v_mfma_f32_16x16x32_bf16 v[88:91], a[48:51], a[224:227], v[88:91]
    v_mfma_f32_16x16x32_bf16 v[92:95], a[52:55], a[224:227], v[92:95]
    s_waitcnt lgkmcnt(0)
    s_barrier
    v_mfma_f32_16x16x32_bf16 v[96:99], a[56:59], a[224:227], v[96:99]
    ds_read_b128 v[192:195], v27 offset:1792
    v_mfma_f32_16x16x32_bf16 v[100:103], a[60:63], a[224:227], v[100:103]
    ds_read_b128 v[196:199], v27 offset:1856
    s_waitcnt vmcnt(7)
    v_mfma_f32_16x16x32_bf16 v[88:91], a[64:67], a[228:231], v[88:91]
    ds_read_b128 v[200:203], v27 offset:1920
    v_mfma_f32_16x16x32_bf16 v[92:95], a[68:71], a[228:231], v[92:95]
    ds_read_b128 v[204:207], v27 offset:1984
    v_mfma_f32_16x16x32_bf16 v[96:99], a[72:75], a[228:231], v[96:99]
    ds_read2st64_b64 v[144:147], v22 offset0:0 offset1:1
    ds_read2st64_b64 v[148:151], v22 offset0:2 offset1:3
    v_mfma_f32_16x16x32_bf16 v[100:103], a[76:79], a[228:231], v[100:103]
    ds_read2st64_b64 v[152:155], v22 offset0:4 offset1:5
    s_waitcnt vmcnt(6)
    v_mfma_f32_16x16x32_bf16 v[88:91], a[80:83], a[232:235], v[88:91]
    ds_read2st64_b64 v[156:159], v22 offset0:6 offset1:7
    v_mfma_f32_16x16x32_bf16 v[92:95], a[84:87], a[232:235], v[92:95]
    ds_read2st64_b64 v[160:163], v22 offset0:8 offset1:9
    ds_read2st64_b64 v[164:167], v22 offset0:10 offset1:11
    v_mfma_f32_16x16x32_bf16 v[96:99], a[88:91], a[232:235], v[96:99]
    ds_read2st64_b64 v[168:171], v22 offset0:12 offset1:13
    s_waitcnt vmcnt(0)
    v_cmp_ne_u64 vcc, s[0:1], v[62:63]
    s_add_u32 m0, s47, 8192
    s_add_u32 s6, s54, 138240
    s_cmp_eq_u64 vcc, 0
    s_cselect_b32 s28, 1, 0
    s_cbranch_scc0 L_noz
    buffer_load_dwordx4 v17, s[76:79], s54 offen sc1 lds
    buffer_load_dwordx4 v17, s[76:79], s6 offen offset:1024 sc1 lds
L_noz:
    buffer_load_dwordx2 v[62:63], v21, s[76:79], 0 offen sc1
    v_mfma_f32_16x16x32_bf16 v[100:103], a[92:95], a[232:235], v[100:103]
    ds_read2st64_b64 v[172:175], v22 offset0:14 offset1:15
    v_mfma_f32_16x16x32_bf16 v[88:91], a[96:99], a[236:239], v[88:91]
    ds_read2st64_b64 v[176:179], v22 offset0:16 offset1:17
    ds_read2st64_b64 v[180:183], v22 offset0:18 offset1:19
    v_mfma_f32_16x16x32_bf16 v[92:95], a[100:103], a[236:239], v[92:95]
    ds_read2st64_b64 v[184:187], v22 offset0:20 offset1:21
    ds_read2st64_b64 v[188:191], v22 offset0:22 offset1:23
    v_mfma_f32_16x16x32_bf16 v[96:99], a[104:107], a[236:239], v[96:99]
    v_mfma_f32_16x16x32_bf16 v[100:103], a[108:111], a[236:239], v[100:103]
    v_mfma_f32_16x16x32_bf16 v[88:91], a[112:115], a[240:243], v[88:91]
    v_mfma_f32_16x16x32_bf16 v[92:95], a[116:119], a[240:243], v[92:95]
    v_mfma_f32_16x16x32_bf16 v[96:99], a[120:123], a[240:243], v[96:99]
    s_waitcnt lgkmcnt(0)
    v_add_f32 v144, v144, v160
    v_mfma_f32_16x16x32_bf16 v[100:103], a[124:127], a[240:243], v[100:103]
    v_add_f32 v192, v192, v176
    v_mfma_f32_16x16x32_bf16 v[88:91], a[128:131], a[244:247], v[88:91]
    v_add_f32 v145, v145, v161
    v_add_f32 v193, v193, v177
    v_mfma_f32_16x16x32_bf16 v[92:95], a[132:135], a[244:247], v[92:95]
    v_add_f32 v146, v146, v162
    v_add_f32 v194, v194, v178
    v_add_f32 v147, v147, v163
    v_mfma_f32_16x16x32_bf16 v[96:99], a[136:139], a[244:247], v[96:99]
    v_add_f32 v195, v195, v179
    v_add_f32 v148, v148, v164
    v_mfma_f32_16x16x32_bf16 v[100:103], a[140:143], a[244:247], v[100:103]
    v_add_f32 v196, v196, v180
    v_add_f32 v149, v149, v165
    v_mfma_f32_16x16x32_bf16 v[88:91], a[144:147], a[248:251], v[88:91]
    v_add_f32 v197, v197, v181
    v_add_f32 v150, v150, v166
    v_add_f32 v198, v198, v182
    v_mfma_f32_16x16x32_bf16 v[92:95], a[148:151], a[248:251], v[92:95]
    v_add_f32 v151, v151, v167
    v_add_f32 v199, v199, v183
    v_mfma_f32_16x16x32_bf16 v[96:99], a[152:155], a[248:251], v[96:99]
    v_add_f32 v152, v152, v168
    v_add_f32 v200, v200, v184
    v_mfma_f32_16x16x32_bf16 v[100:103], a[156:159], a[248:251], v[100:103]
    v_add_f32 v153, v153, v169
    v_add_f32 v201, v201, v185
    v_add_f32 v154, v154, v170
    v_mfma_f32_16x16x32_bf16 v[88:91], a[160:163], a[252:255], v[88:91]
    v_add_f32 v202, v202, v186
    v_add_f32 v155, v155, v171
    v_mfma_f32_16x16x32_bf16 v[92:95], a[164:167], a[252:255], v[92:95]
    v_add_f32 v203, v203, v187
    v_add_f32 v156, v156, v172
    v_mfma_f32_16x16x32_bf16 v[96:99], a[168:171], a[252:255], v[96:99]
    v_add_f32 v204, v204, v188
    v_add_f32 v157, v157, v173
    v_add_f32 v205, v205, v189
    v_mfma_f32_16x16x32_bf16 v[100:103], a[172:175], a[252:255], v[100:103]
    v_add_f32 v158, v158, v174
    v_add_f32 v206, v206, v190
    v_add_f32 v159, v159, v175
    v_add_f32 v207, v207, v191
    s_mov_b32 s10, 0xbfb8aa3b
    s_mov_b32 s11, 0xbfb8aa3b
    s_mov_b64 s[60:61], s[30:31]
    s_mov_b32 s62, 2097152
    s_mov_b32 s63, 0x00020000
.p2align 3
    v_pk_add_f32 v[144:145], v[144:145], v[192:193]
    v_pk_add_f32 v[146:147], v[146:147], v[194:195]
    v_pk_add_f32 v[148:149], v[148:149], v[196:197]
    v_pk_add_f32 v[150:151], v[150:151], v[198:199]
    v_pk_add_f32 v[152:153], v[152:153], v[200:201]
    v_pk_add_f32 v[154:155], v[154:155], v[202:203]
    v_pk_add_f32 v[156:157], v[156:157], v[204:205]
    v_pk_add_f32 v[158:159], v[158:159], v[206:207]
    v_pk_add_f32 v[144:145], v[144:145], v[88:89]
    v_pk_add_f32 v[146:147], v[146:147], v[90:91]
    v_pk_add_f32 v[148:149], v[148:149], v[92:93]
    v_pk_add_f32 v[150:151], v[150:151], v[94:95]
    v_pk_add_f32 v[152:153], v[152:153], v[96:97]
    v_pk_add_f32 v[154:155], v[154:155], v[98:99]
    v_pk_add_f32 v[156:157], v[156:157], v[100:101]
    v_pk_add_f32 v[158:159], v[158:159], v[102:103]
    v_pk_mul_f32 v[160:161], v[144:145], s[10:11]
    v_pk_mul_f32 v[162:163], v[146:147], s[10:11]
    v_pk_mul_f32 v[164:165], v[148:149], s[10:11]
    v_pk_mul_f32 v[166:167], v[150:151], s[10:11]
    v_pk_mul_f32 v[168:169], v[152:153], s[10:11]
    v_pk_mul_f32 v[170:171], v[154:155], s[10:11]
    v_pk_mul_f32 v[172:173], v[156:157], s[10:11]
    v_pk_mul_f32 v[174:175], v[158:159], s[10:11]
    v_exp_f32 v160, v160
    v_exp_f32 v161, v161
    v_exp_f32 v162, v162
    v_exp_f32 v163, v163
    v_exp_f32 v164, v164
    v_exp_f32 v165, v165
    v_exp_f32 v166, v166
    v_exp_f32 v167, v167
    v_exp_f32 v168, v168
    v_exp_f32 v169, v169
    v_exp_f32 v170, v170
    v_exp_f32 v171, v171
    v_exp_f32 v172, v172
    v_exp_f32 v173, v173
    v_exp_f32 v174, v174
    v_exp_f32 v175, v175
    v_pk_mul_f32 v[144:145], v[144:145], v[128:129]
    v_pk_mul_f32 v[146:147], v[146:147], v[130:131]
    v_pk_mul_f32 v[148:149], v[148:149], v[132:133]
    v_pk_mul_f32 v[150:151], v[150:151], v[134:135]
    v_pk_mul_f32 v[152:153], v[152:153], v[136:137]
    v_pk_mul_f32 v[154:155], v[154:155], v[138:139]
    v_pk_mul_f32 v[156:157], v[156:157], v[140:141]
    v_pk_mul_f32 v[158:159], v[158:159], v[142:143]
    v_pk_add_f32 v[160:161], v[160:161], 1.0 op_sel_hi:[1,0]
    v_pk_add_f32 v[162:163], v[162:163], 1.0 op_sel_hi:[1,0]
    v_pk_add_f32 v[164:165], v[164:165], 1.0 op_sel_hi:[1,0]
    v_pk_add_f32 v[166:167], v[166:167], 1.0 op_sel_hi:[1,0]
    v_pk_add_f32 v[168:169], v[168:169], 1.0 op_sel_hi:[1,0]
    v_pk_add_f32 v[170:171], v[170:171], 1.0 op_sel_hi:[1,0]
    v_pk_add_f32 v[172:173], v[172:173], 1.0 op_sel_hi:[1,0]
    v_pk_add_f32 v[174:175], v[174:175], 1.0 op_sel_hi:[1,0]
    v_rcp_f32 v160, v160
    v_rcp_f32 v161, v161
    v_rcp_f32 v162, v162
    v_rcp_f32 v163, v163
    v_rcp_f32 v164, v164
    v_rcp_f32 v165, v165
    v_rcp_f32 v166, v166
    v_rcp_f32 v167, v167
    v_rcp_f32 v168, v168
    v_rcp_f32 v169, v169
    v_rcp_f32 v170, v170
    v_rcp_f32 v171, v171
    v_rcp_f32 v172, v172
    v_rcp_f32 v173, v173
    v_rcp_f32 v174, v174
    v_rcp_f32 v175, v175
    s_cmp_eq_u32 s28, 1
    s_cbranch_scc1 L_havez
    s_waitcnt vmcnt(0)
    v_cmp_ne_u64 vcc, s[0:1], v[62:63]
    s_nop 0
    s_cmp_eq_u64 vcc, 0
    s_cbranch_scc0 L_pf3b
L_pf3b_ok:
    buffer_load_dwordx4 v17, s[76:79], s54 offen sc1 lds
    buffer_load_dwordx4 v17, s[76:79], s6 offen offset:1024 sc1 lds
L_havez:
    s_or_b32 s5, s2, s36
    s_cbranch_scc0 L_bump
L_bumped:
    s_waitcnt vmcnt(0)
L_bumped2:
    ds_read_b64_tr_b16 v[38:39], v18 offset:8192
    ds_read_b64_tr_b16 v[40:41], v18 offset:8704
    ds_read_b64_tr_b16 v[42:43], v18 offset:9216
    ds_read_b64_tr_b16 v[44:45], v18 offset:9728
    v_pk_mul_f32 v[144:145], v[144:145], v[160:161]
    v_pk_mul_f32 v[146:147], v[146:147], v[162:163]
    v_pk_mul_f32 v[148:149], v[148:149], v[164:165]
    v_pk_mul_f32 v[150:151], v[150:151], v[166:167]
    v_pk_mul_f32 v[152:153], v[152:153], v[168:169]
    v_pk_mul_f32 v[154:155], v[154:155], v[170:171]
    v_pk_mul_f32 v[156:157], v[156:157], v[172:173]
    v_pk_mul_f32 v[158:159], v[158:159], v[174:175]
    s_waitcnt lgkmcnt(3)
    v_lshlrev_b32 v160, 16, v38
    v_and_b32 v161, s48, v38
    v_lshlrev_b32 v162, 16, v39
    v_and_b32 v163, s48, v39
    v_pk_fma_f32 v[144:145], v[144:145], v[160:161], v[112:113]
    v_pk_fma_f32 v[146:147], v[146:147], v[162:163], v[114:115]
    v_cvt_pk_bf16_f32 v38, v144, v145
    v_cvt_pk_bf16_f32 v39, v146, v147
    ds_write_b64 v57, v[38:39] offset:10240
    s_waitcnt lgkmcnt(3)
    v_lshlrev_b32 v164, 16, v40
    v_and_b32 v165, s48, v40
    v_lshlrev_b32 v166, 16, v41
    v_and_b32 v167, s48, v41
    v_pk_fma_f32 v[148:149], v[148:149], v[164:165], v[116:117]
    v_pk_fma_f32 v[150:151], v[150:151], v[166:167], v[118:119]
    v_cvt_pk_bf16_f32 v40, v148, v149
    v_cvt_pk_bf16_f32 v41, v150, v151
    ds_write_b64 v58, v[40:41] offset:10240
    s_waitcnt lgkmcnt(3)
    v_lshlrev_b32 v168, 16, v42
    v_and_b32 v169, s48, v42
    v_lshlrev_b32 v170, 16, v43
    v_and_b32 v171, s48, v43
    v_pk_fma_f32 v[152:153], v[152:153], v[168:169], v[120:121]
    v_pk_fma_f32 v[154:155], v[154:155], v[170:171], v[122:123]
    v_cvt_pk_bf16_f32 v42, v152, v153
    v_cvt_pk_bf16_f32 v43, v154, v155
    ds_write_b64 v59, v[42:43] offset:10240
    s_waitcnt lgkmcnt(3)
    v_lshlrev_b32 v172, 16, v44
    v_and_b32 v173, s48, v44
    v_lshlrev_b32 v174, 16, v45
    v_and_b32 v175, s48, v45
    v_pk_fma_f32 v[156:157], v[156:157], v[172:173], v[124:125]
    v_pk_fma_f32 v[158:159], v[158:159], v[174:175], v[126:127]
    v_cvt_pk_bf16_f32 v44, v156, v157
    v_cvt_pk_bf16_f32 v45, v158, v159
    ds_write_b64 v60, v[44:45] offset:10240
    ds_read_b128 v[176:179], v12 offset:10240
    ds_read_b128 v[180:183], v12 offset:11264
    s_waitcnt lgkmcnt(1)
    buffer_store_dwordx4 v[176:179], v34, s[60:63], s46 offen
    s_waitcnt lgkmcnt(0)
    buffer_store_dwordx4 v[180:183], v35, s[60:63], s46 offen offset:1024
L_end:
    s_endpgm
L_sg:
L_sg_l:
    s_sleep 2
    buffer_load_dwordx4 v[246:249], v26, s[76:79], 0 offen sc1
    s_waitcnt vmcnt(0)
    v_cmp_ne_u64 vcc, s[0:1], v[248:249]
    s_nop 0
    s_cmp_eq_u64 vcc, 0
    s_cbranch_scc0 L_sg_l
    s_branch L_sg_ok
L_gskip0:
    ds_write_b128 v24, v[156:159] offset:12480
    ds_write_b128 v24, v[170:173] offset:8320
    buffer_store_dwordx4 v[80:83], v11, s[76:79], s20 offen sc1
    s_add_u32 s20, s20, 44032
    ds_write_b128 v24, v[162:165] offset:13504
    ds_write_b128 v24, v[182:185] offset:9344
    buffer_store_dwordx4 v[84:87], v11, s[76:79], s20 offen sc1
    s_branch L_gdone0
L_pf1:
L_pf1_l:
    s_sleep 1
    buffer_load_dwordx2 v[62:63], v19, s[76:79], 0 offen sc1
    s_waitcnt vmcnt(0)
    v_cmp_ne_u64 vcc, s[0:1], v[62:63]
    s_nop 0
    s_cmp_eq_u64 vcc, 0
    s_cbranch_scc0 L_pf1_l
    s_branch L_pf1_ok
L_gskip1:
    buffer_load_dwordx4 v11, s[60:63], s56 offen offset:0 sc1 lds
    ds_write_b128 v24, v[166:169] offset:0
    buffer_load_dwordx4 v11, s[60:63], s56 offen offset:1024 sc1 lds
    buffer_load_dwordx4 v11, s[60:63], s56 offen offset:2048 sc1 lds
    ds_write_b128 v24, v[174:177] offset:4160
    buffer_load_dwordx4 v11, s[60:63], s56 offen offset:3072 sc1 lds
    buffer_store_dwordx4 v[80:83], v11, s[76:79], s21 offen sc1
    s_add_u32 s21, s21, 44032
    ds_write_b128 v24, v[178:181] offset:1024
    ds_write_b128 v24, v[186:189] offset:5184
    buffer_store_dwordx4 v[84:87], v11, s[76:79], s21 offen sc1
    s_branch L_gdone1
L_gskip2:
    buffer_store_dwordx4 v[80:83], v11, s[76:79], s22 offen sc1
    s_add_u32 s22, s22, 44032
    s_waitcnt vmcnt(3) lgkmcnt(0)
    s_barrier
    ds_read_b128 a[204:207], v13 offset:3584
    ds_read_b128 a[208:211], v14 offset:3584
    ds_read_b128 a[200:203], v13 offset:3072
    ds_read_b128 a[212:215], v14 offset:3072
    ds_read_b128 a[196:199], v13 offset:2560
    ds_read_b128 a[216:219], v14 offset:2560
    buffer_store_dwordx4 v[84:87], v11, s[76:79], s22 offen sc1
    s_branch L_gdone2
L_pf2:
    s_waitcnt vmcnt(0)
    s_mov_b64 exec, 15
    buffer_store_dwordx4 v[30:33], v11, s[76:79], s52 offen sc1
    s_mov_b64 exec, -1
L_pf2_l:
    s_sleep 1
    buffer_load_dwordx2 v[62:63], v20, s[76:79], 0 offen sc1
    s_waitcnt vmcnt(0)
    v_cmp_ne_u64 vcc, s[0:1], v[62:63]
    s_nop 0
    s_cmp_eq_u64 vcc, 0
    s_cbranch_scc0 L_pf2_l
    s_branch L_pf2_ok
L_sv:
L_sv_l:
    s_sleep 2
    buffer_load_dwordx4 v[38:41], v23, s[76:79], 0 offen sc1
    s_waitcnt vmcnt(0)
    v_cmp_ne_u64 vcc, s[0:1], v[40:41]
    s_nop 0
    s_cmp_eq_u64 vcc, 0
    s_cbranch_scc0 L_sv_l
    s_branch L_sv_ok
L_pf3b:
L_pf3b_l:
    s_sleep 1
    buffer_load_dwordx2 v[62:63], v21, s[76:79], 0 offen sc1
    s_waitcnt vmcnt(0)
    v_cmp_ne_u64 vcc, s[0:1], v[62:63]
    s_nop 0
    s_cmp_eq_u64 vcc, 0
    s_cbranch_scc0 L_pf3b_l
    s_branch L_pf3b_ok
L_bump:
    v_and_b32 v2, 7, v1
    v_lshrrev_b32 v3, 1, v2
    v_and_b32 v2, 1, v2
    v_mul_u32_u24 v3, 4608, v3
    v_lshl_add_u32 v2, v2, 9, v3
    s_mov_b32 s5, 10944512
L_bump_l:
    buffer_load_dwordx2 v[62:63], v2, s[76:79], s5 offen sc1
    s_waitcnt vmcnt(0)
    v_cmp_ne_u64 vcc, s[0:1], v[62:63]
    s_nop 0
    s_cmp_eq_u64 vcc, 0
    s_cbranch_scc0 L_bump_l
    s_mov_b32 s5, 11534336
    s_mov_b64 exec, 1
    buffer_store_dwordx2 v[30:31], v8, s[76:79], s5 offen sc1
    s_mov_b64 exec, -1
    s_branch L_bumped2
    s_endpgm
.section .rodata,"a"
.p2align 6
.amdhsa_kernel recurrent_scan__ssm_conv_h3__mixer_channel_mlp__prompt_kernel
  .amdhsa_next_free_vgpr 512
  .amdhsa_next_free_sgpr 102
  .amdhsa_accum_offset 256
  .amdhsa_group_segment_fixed_size 0
  .amdhsa_kernarg_size 112
  .amdhsa_user_sgpr_count 2
  .amdhsa_user_sgpr_kernarg_segment_ptr 1
  .amdhsa_system_sgpr_workgroup_id_x 1
.end_amdhsa_kernel
```
